```python
import torch

def _softmax(x, axis=-1):
    return torch.softmax(x, dim=axis)
def _gelu(x):
    return torch.nn.functional.gelu(x, approximate="tanh")
def _silu(x):
    return torch.nn.functional.silu(x)
def _sigmoid(x):
    return torch.sigmoid(x)
def _layernorm(x, axis=-1, eps=1e-5):
    m = x.mean(dim=axis, keepdim=True)
    v = x.var(dim=axis, keepdim=True, unbiased=False)
    return (x - m) / torch.sqrt(v + eps)
def _scatter_add(tgt, idx, src, axis=0):
    return tgt.clone().index_add_(axis, idx, src)
def _segment_sum(src, seg, n):
    out = torch.zeros((n,) + src.shape[1:], dtype=src.dtype)
    return out.index_add_(0, seg, src)
def _pad(x, pw):
    flat = tuple(v for pair in reversed(pw) for v in pair)
    return torch.nn.functional.pad(x, flat)

kernel_name = 'standalone__gqa_block_cached__near_ridge'

def setup_inputs():

    _w = (lambda a: (lambda t: t.to(torch.bfloat16) if t.is_floating_point() else t)(torch.as_tensor(a)))
    B, Sq, D = 16, 96, 448
    Hq, Hkv, Sk, Dh = 16, 8, 1024, 256
    assert Hq % Hkv == 0, (Hq, Hkv)
    return {
        "x": _w((lambda *s: torch.randn(*s, dtype=torch.bfloat16) * 0.8)(B, Sq, D)),
        "k_cache": _w((lambda *s: torch.randn(*s, dtype=torch.bfloat16) * 0.8)(B, Hkv, Sk, Dh)),
        "v_cache": _w((lambda *s: torch.randn(*s, dtype=torch.bfloat16) * 0.05)(B, Hkv, Sk, Dh)),
        "wq": _w((lambda *s: torch.randn(*s, dtype=torch.bfloat16) * 0.8)(D, Hq * Dh) * (D ** -0.5)),
        "wo": _w((lambda *s: torch.randn(*s, dtype=torch.bfloat16) * 0.05)(Hq * Dh, D) * ((Hq * Dh) ** -0.5)),
    }

def reference(x, k_cache, v_cache, wq, wo):
    B, Sq, D = x.shape
    Hq, Dh = 16, 256
    Hkv = k_cache.shape[1]
    rep = Hq // Hkv
    q = (lambda x, *d: x.permute(*d))((x @ wq).reshape(B, Sq, Hq, Dh), 0, 2, 1, 3)
    k = (lambda x, n, axis: torch.repeat_interleave(x, n, dim=axis))(k_cache, rep, axis=1)
    v = (lambda x, n, axis: torch.repeat_interleave(x, n, dim=axis))(v_cache, rep, axis=1)
    scores = torch.einsum("bhqd,bhkd->bhqk", q, k) * (Dh ** -0.5)
    p = _softmax(scores, axis=-1)
    o = torch.einsum("bhqk,bhkd->bhqd", p, v)
    return (lambda x, *d: x.permute(*d))(o, 0, 2, 1, 3).reshape(B, Sq, Hq * Dh) @ wo
```

```asm
; @launch grid=(256,1,1) block=(256,1,1) lds=163840
.amdgcn_target "amdgcn-amd-amdhsa--gfx950"
.text
.globl standalone__gqa_block_cached__near_ridge_kernel
.p2align 8
.type standalone__gqa_block_cached__near_ridge_kernel,@function
standalone__gqa_block_cached__near_ridge_kernel:
    s_getpc_b64 s[92:93]
    s_load_dwordx2 s[4:5], s[0:1], 0
    s_load_dwordx2 s[16:17], s[0:1], 24
    s_load_dwordx2 s[8:9], s[0:1], 8
    s_load_dwordx2 s[12:13], s[0:1], 16
    s_load_dwordx2 s[24:25], s[0:1], 56
    s_cmp_ge_u32 s2, 256
    s_cbranch_scc1 L_done
    s_lshr_b32 s3, s2, 3
    s_lshl_b32 s3, s3, 11
    v_lshrrev_b32 v20, 4, v0
    v_lshl_add_u32 v20, v20, 7, s3
    v_min_u32 v20, L_code_end-standalone__gqa_block_cached__near_ridge_kernel-8, v20
    v_mov_b32 v23, s93
    v_add_co_u32 v22, vcc, s92, v20
    s_nop 1
    v_addc_co_u32 v23, vcc, 0, v23, vcc
    global_load_dword v31, v[22:23], off
    v_lshrrev_b32 v20, 6, v0
    v_and_b32 v1, 63, v0
    v_readfirstlane_b32 s28, v20
    s_lshr_b32 s29, s2, 4
    s_and_b32 s45, s2, 7
    s_lshr_b32 s46, s2, 3
    s_and_b32 s46, s46, 1
    s_lshl_b32 s30, s45, 1
    s_add_u32 s30, s30, s46
    s_lshl_b32 s32, s29, 3
    s_add_u32 s32, s32, s45
    s_lshl_b32 s32, s32, 19
    s_mov_b32 s33, s32
    s_mul_i32 s45, s29, 37
    s_lshr_b32 s45, s45, 8
    s_mul_i32 s45, s45, 7
    s_sub_u32 s44, s29, s45
    s_mul_i32 s46, s46, 3
    s_add_u32 s31, s44, s46
    s_sub_u32 s45, s31, 7
    s_cmp_ge_u32 s31, 7
    s_cselect_b32 s31, s45, s31
    s_lshl_b32 s53, s28, 10
    s_mul_i32 s54, s29, 86016
    s_mul_i32 s45, s28, 7168
    s_add_u32 s54, s54, s45
    s_lshl_b32 s55, s30, 9
    s_lshl_b32 s46, s28, 7
    s_add_u32 s55, s55, s46
    s_mul_i32 s56, s30, 229376
    s_add_u32 s56, s56, s45
    s_lshl_b32 s49, s28, 14
    s_add_u32 s49, s49, 92160
    v_lshrrev_b32 v20, 3, v1
    v_and_b32 v21, 7, v1
    v_lshrrev_b32 v22, 1, v20
    v_xor_b32 v22, v22, v21
    s_and_b32 s45, s28, 1
    s_lshl_b32 s46, s45, 2
    v_xor_b32 v22, s46, v22
    v_mul_u32_u24 v23, 896, v20
    v_lshl_add_u32 v250, v22, 4, v23
    v_and_b32 v22, 6, v20
    v_xor_b32 v22, v22, v21
    v_lshl_add_u32 v12, v22, 4, v23
    v_and_b32 v23, 4, v20
    v_add_u32 v23, v23, v20
    v_lshlrev_b32 v23, 13, v23
    v_lshl_add_u32 v251, v22, 4, v23
    s_mov_b32 s47, s31
    s_mov_b32 s48, s31
    s_mov_b32 s6, 1376256
    s_mov_b32 s7, 0x20000
    s_mov_b32 s18, 3670016
    s_mov_b32 s19, 0x20000
    s_waitcnt lgkmcnt(0)
    s_lshl_b32 s40, s47, 7
    s_add_u32 s40, s40, s54
    s_add_u32 m0, s53, 0
    s_add_u32 s47, s47, 1
    s_cmp_eq_u32 s47, 7
    s_cselect_b32 s47, 0, s47
    buffer_load_dwordx4 v250, s[4:7], s40 offen  lds
    s_add_u32 m0, s53, 4096
    s_add_u32 s40, s40, 28672
    buffer_load_dwordx4 v250, s[4:7], s40 offen  lds
    s_add_u32 m0, s53, 8192
    s_add_u32 s40, s40, 28672
    buffer_load_dwordx4 v250, s[4:7], s40 offen  lds
    s_lshl_b32 s41, s48, 19
    s_add_u32 s41, s41, s55
    s_add_u32 s48, s48, 1
    s_cmp_eq_u32 s48, 7
    s_cselect_b32 s48, 0, s48
    s_add_u32 m0, s49, 0
    s_add_u32 s58, s41, 0
    buffer_load_dwordx4 v251, s[16:19], s58 offen  lds
    s_add_u32 m0, s49, 1024
    s_add_u32 s58, s41, 131072
    buffer_load_dwordx4 v251, s[16:19], s58 offen  lds
    s_add_u32 m0, s49, 2048
    s_add_u32 s58, s41, 32768
    buffer_load_dwordx4 v251, s[16:19], s58 offen  lds
    s_add_u32 m0, s49, 3072
    s_add_u32 s58, s41, 163840
    buffer_load_dwordx4 v251, s[16:19], s58 offen  lds
    s_load_dwordx2 s[20:21], s[0:1], 32
    s_load_dwordx2 s[84:85], s[0:1], 40
    s_load_dwordx2 s[88:89], s[0:1], 48
    s_mov_b32 s10, 67108864
    s_mov_b32 s11, 0x20000
    s_mov_b32 s14, 67108864
    s_mov_b32 s15, 0x20000
    s_mov_b32 s22, 3670016
    s_mov_b32 s23, 0x20000
    s_mov_b32 s26, 22089728
    s_mov_b32 s27, 0x20000
    s_mov_b32 s86, 1376256
    s_mov_b32 s87, 0x20000
    s_mov_b32 s90, 256
    s_mov_b32 s91, 0x20000
    s_lshl_b32 s34, s29, 8
    s_add_u32 s34, s34, 22085632
    s_or_b32 s3, s30, s28
    s_cmp_eq_u32 s3, 0
    s_cselect_b32 s35, 0, 0x40000000
    s_add_u32 s3, s34, s35
    v_lshlrev_b32 v243, 2, v1
    v_mov_b32 v244, 0
    buffer_store_dword v244, v243, s[24:27], s3 offen sc1
    v_and_b32 v243, 60, v243
    s_mul_i32 s38, s28, 1056
    s_lshl_b32 s57, s29, 4
    s_add_u32 s57, s57, s30
    s_mul_i32 s57, s57, 86272
    s_lshl_b32 s3, s28, 8
    s_add_u32 s57, s57, s3
    s_mov_b32 s36, 0x3db8aa3b
    s_mov_b32 s37, 0x41400000
    v_lshrrev_b32 v20, 4, v1
    v_and_b32 v21, 15, v1
    s_lshr_b32 s46, s28, 1
    v_lshlrev_b32 v11, 4, v1
    v_lshrrev_b32 v22, 5, v1
    v_and_b32 v23, 31, v1
    v_lshlrev_b32 v22, 12, v22
    v_lshl_add_u32 v22, v23, 4, v22
    s_lshl_b32 s3, s28, 9
    v_add_u32 v2, s3, v22
    v_add_u32 v3, 8192, v2
    v_add_u32 v4, 16384, v2
    v_add_u32 v5, 24576, v2
    v_and_b32 v22, 7, v21
    v_mul_u32_u24 v22, 1056, v22
    v_lshrrev_b32 v23, 3, v21
    v_lshl_add_u32 v22, v23, 9, v22
    v_lshl_add_u32 v22, v20, 4, v22
    s_mul_i32 s3, s46, 16896
    v_add_u32 v6, s3, v22
    v_bfe_u32 v22, v1, 2, 3
    v_mul_u32_u24 v22, 1056, v22
    v_lshrrev_b32 v23, 5, v1
    v_lshl_add_u32 v22, v23, 9, v22
    v_and_b32 v23, 3, v1
    v_lshl_add_u32 v22, v23, 3, v22
    s_mul_i32 s3, s46, 17152
    s_add_u32 s3, s3, 67584
    v_add_u32 v7, s3, v22
    s_mul_i32 s3, s46, -16640
    s_add_u32 s3, s3, 84480
    v_add_u32 v8, s3, v22
    s_mul_i32 s3, s28, 3072
    s_add_u32 s3, s3, 135168
    v_add_u32 v9, s3, v11
    v_lshl_add_u32 v29, v21, 4, s3
    v_lshl_add_u32 v28, v20, 2, v29
    s_xor_b32 s3, s28, 2
    s_mul_i32 s3, s3, 3072
    s_add_u32 s3, s3, 135168
    v_add_u32 v10, s3, v11
    v_lshl_add_u32 v30, v21, 4, s3
    v_add_u32 v15, 101376, v11
    v_mov_b32 v14, 163584
    v_lshrrev_b32 v22, 2, v21
    v_lshlrev_b32 v22, 10, v22
    v_lshl_add_u32 v22, v20, 6, v22
    v_lshl_add_u32 v240, v23, 4, v22
    v_add_u32 v241, 4096, v240
    v_add_u32 v242, 8192, v240
    v_lshrrev_b32 v19, 2, v1
    v_lshlrev_b32 v19, 7, v19
    v_lshl_add_u32 v19, v23, 3, v19
    v_bfe_u32 v22, v1, 3, 2
    v_xor_b32 v23, s28, v22
    v_lshl_add_u32 v13, v23, 5, v19
    v_add_u32 v19, s49, v19
    v_xor_b32 v23, 0, v22
    v_lshl_add_u32 v24, v23, 5, v19
    v_xor_b32 v23, 1, v22
    v_lshl_add_u32 v25, v23, 5, v19
    v_xor_b32 v23, 2, v22
    v_lshl_add_u32 v26, v23, 5, v19
    v_xor_b32 v23, 3, v22
    v_lshl_add_u32 v27, v23, 5, v19
    v_lshrrev_b32 v22, 1, v21
    v_xor_b32 v22, v22, v20
    v_lshlrev_b32 v22, 4, v22
    v_lshl_add_u32 v252, v21, 7, v22
    v_xor_b32 v253, 64, v252
    v_lshrrev_b32 v22, 1, v20
    v_lshlrev_b32 v22, 8, v22
    v_and_b32 v23, 1, v20
    v_lshl_add_u32 v22, v23, 3, v22
    v_lshl_add_u32 v22, v21, 4, v22
    s_mul_i32 s3, s28, 12288
    s_add_u32 s3, s3, 113664
    v_add_u32 v248, s3, v22
    s_mul_i32 s3, s45, 3072
    s_add_u32 s3, s3, 113664
    v_add_u32 v249, s3, v11
    s_mul_i32 s3, s28, 6144
    s_add_u32 s3, s3, 101376
    v_add_u32 v254, s3, v11
    v_mov_b32 v104, 0
    v_mov_b32 v105, 0
    v_mov_b32 v106, 0
    v_mov_b32 v107, 0
    v_mov_b32 v108, 0
    v_mov_b32 v109, 0
    v_mov_b32 v110, 0
    v_mov_b32 v111, 0
    v_mov_b32 v112, 0
    v_mov_b32 v113, 0
    v_mov_b32 v114, 0
    v_mov_b32 v115, 0
    v_mov_b32 v116, 0x3f803f80
    v_mov_b32 v117, 0x3f803f80
    v_mov_b32 v118, 0x3f803f80
    v_mov_b32 v119, 0x3f803f80
    ds_write_b32 v14, v104
    s_add_u32 m0, s49, 4096
    s_add_u32 s58, s41, 262144
    buffer_load_dwordx4 v251, s[16:19], s58 offen  lds
    s_add_u32 m0, s49, 5120
    s_add_u32 s58, s41, 393216
    buffer_load_dwordx4 v251, s[16:19], s58 offen  lds
    s_add_u32 m0, s49, 6144
    s_add_u32 s58, s41, 294912
    buffer_load_dwordx4 v251, s[16:19], s58 offen  lds
    s_add_u32 m0, s49, 7168
    s_add_u32 s58, s41, 425984
    buffer_load_dwordx4 v251, s[16:19], s58 offen  lds
    s_waitcnt vmcnt(9)
    s_waitcnt lgkmcnt(0)
    s_barrier
    ds_read_b128 a[96:99], v252 offset:0
    ds_read_b128 a[100:103], v252 offset:2048
    ds_read_b128 a[104:107], v252 offset:4096
    s_waitcnt vmcnt(5)
    ds_read_b64_tr_b16 a[160:161], v24 offset:0
    ds_read_b64_tr_b16 a[162:163], v24 offset:2048
    ds_read_b64_tr_b16 a[164:165], v25 offset:0
    ds_read_b64_tr_b16 a[166:167], v25 offset:2048
    ds_read_b64_tr_b16 a[168:169], v26 offset:0
    ds_read_b64_tr_b16 a[170:171], v26 offset:2048
    ds_read_b64_tr_b16 a[172:173], v27 offset:0
    ds_read_b64_tr_b16 a[174:175], v27 offset:2048
    ds_read_b128 a[108:111], v252 offset:6144
    ds_read_b128 a[112:115], v252 offset:8192
    ds_read_b128 a[116:119], v252 offset:10240
    s_waitcnt lgkmcnt(9)
    v_mfma_f32_16x16x32_bf16 v[120:123], a[160:163], a[96:99], 0
    s_lshl_b32 s40, s47, 7
    s_add_u32 s40, s40, s54
    s_add_u32 m0, s53, 12288
    s_add_u32 s47, s47, 1
    s_cmp_eq_u32 s47, 7
    s_cselect_b32 s47, 0, s47
    s_waitcnt lgkmcnt(7)
    v_mfma_f32_16x16x32_bf16 v[144:147], a[164:167], a[96:99], 0
    buffer_load_dwordx4 v250, s[4:7], s40 offen  lds
    s_waitcnt lgkmcnt(5)
    v_mfma_f32_16x16x32_bf16 v[168:171], a[168:171], a[96:99], 0
    s_add_u32 m0, s53, 16384
    s_add_u32 s40, s40, 28672
    s_waitcnt lgkmcnt(3)
    v_mfma_f32_16x16x32_bf16 v[192:195], a[172:175], a[96:99], 0
    buffer_load_dwordx4 v250, s[4:7], s40 offen  lds
    v_mfma_f32_16x16x32_bf16 v[124:127], a[160:163], a[100:103], 0
    s_add_u32 m0, s53, 20480
    s_add_u32 s40, s40, 28672
    v_mfma_f32_16x16x32_bf16 v[148:151], a[164:167], a[100:103], 0
    buffer_load_dwordx4 v250, s[4:7], s40 offen  lds
    v_mfma_f32_16x16x32_bf16 v[172:175], a[168:171], a[100:103], 0
    ds_read_b128 a[120:123], v253 offset:0
    s_lshl_b32 s41, s48, 19
    s_add_u32 s41, s41, s55
    s_add_u32 s48, s48, 1
    s_cmp_eq_u32 s48, 7
    s_cselect_b32 s48, 0, s48
    s_add_u32 m0, s49, 8192
    s_add_u32 s58, s41, 0
    v_mfma_f32_16x16x32_bf16 v[196:199], a[172:175], a[100:103], 0
    ds_read_b128 a[124:127], v253 offset:2048
    buffer_load_dwordx4 v251, s[16:19], s58 offen  lds
    v_mfma_f32_16x16x32_bf16 v[128:131], a[160:163], a[104:107], 0
    ds_read_b128 a[128:131], v253 offset:4096
    s_add_u32 m0, s49, 9216
    s_add_u32 s58, s41, 131072
    v_mfma_f32_16x16x32_bf16 v[152:155], a[164:167], a[104:107], 0
    s_waitcnt vmcnt(4)
    buffer_load_dwordx4 v251, s[16:19], s58 offen  lds
    v_mfma_f32_16x16x32_bf16 v[176:179], a[168:171], a[104:107], 0
    ds_read_b64_tr_b16 a[176:177], v24 offset:4096
    s_add_u32 m0, s49, 10240
    s_add_u32 s58, s41, 32768
    v_mfma_f32_16x16x32_bf16 v[200:203], a[172:175], a[104:107], 0
    buffer_load_dwordx4 v251, s[16:19], s58 offen  lds
    s_waitcnt lgkmcnt(6)
    v_mfma_f32_16x16x32_bf16 v[132:135], a[160:163], a[108:111], 0
    ds_read_b64_tr_b16 a[178:179], v24 offset:6144
    ds_read_b64_tr_b16 a[180:181], v25 offset:4096
    v_mfma_f32_16x16x32_bf16 v[156:159], a[164:167], a[108:111], 0
    s_add_u32 m0, s49, 11264
    s_add_u32 s58, s41, 163840
    v_mfma_f32_16x16x32_bf16 v[180:183], a[168:171], a[108:111], 0
    ds_read_b64_tr_b16 a[182:183], v25 offset:6144
    buffer_load_dwordx4 v251, s[16:19], s58 offen  lds
    v_mfma_f32_16x16x32_bf16 v[204:207], a[172:175], a[108:111], 0
    ds_read_b64_tr_b16 a[184:185], v26 offset:4096
    s_add_u32 m0, s49, 12288
    s_add_u32 s58, s41, 262144
    s_waitcnt lgkmcnt(9)
    v_mfma_f32_16x16x32_bf16 v[136:139], a[160:163], a[112:115], 0
    buffer_load_dwordx4 v251, s[16:19], s58 offen  lds
    v_mfma_f32_16x16x32_bf16 v[160:163], a[164:167], a[112:115], 0
    ds_read_b64_tr_b16 a[186:187], v26 offset:6144
    s_add_u32 m0, s49, 13312
    s_add_u32 s58, s41, 393216
    v_mfma_f32_16x16x32_bf16 v[184:187], a[168:171], a[112:115], 0
    ds_read_b64_tr_b16 a[188:189], v27 offset:4096
    buffer_load_dwordx4 v251, s[16:19], s58 offen  lds
    v_mfma_f32_16x16x32_bf16 v[208:211], a[172:175], a[112:115], 0
    ds_read_b64_tr_b16 a[190:191], v27 offset:6144
    ds_read_b128 a[132:135], v253 offset:6144
    ds_read_b128 a[136:139], v253 offset:8192
    ds_read_b128 a[140:143], v253 offset:10240
    s_add_u32 m0, s49, 14336
    s_add_u32 s58, s41, 294912
    s_waitcnt lgkmcnt(14)
    v_mfma_f32_16x16x32_bf16 v[140:143], a[160:163], a[116:119], 0
    buffer_load_dwordx4 v251, s[16:19], s58 offen  lds
    v_mfma_f32_16x16x32_bf16 v[164:167], a[164:167], a[116:119], 0
    s_add_u32 m0, s49, 15360
    s_add_u32 s58, s41, 425984
    v_mfma_f32_16x16x32_bf16 v[188:191], a[168:171], a[116:119], 0
    buffer_load_dwordx4 v251, s[16:19], s58 offen  lds
    v_mfma_f32_16x16x32_bf16 v[212:215], a[172:175], a[116:119], 0
    s_waitcnt lgkmcnt(9)
    v_mfma_f32_16x16x32_bf16 v[120:123], a[176:179], a[120:123], v[120:123]
    s_lshl_b32 s40, s47, 7
    s_add_u32 s40, s40, s54
    s_add_u32 m0, s53, 24576
    s_add_u32 s47, s47, 1
    s_cmp_eq_u32 s47, 7
    s_cselect_b32 s47, 0, s47
    s_waitcnt lgkmcnt(7)
    v_mfma_f32_16x16x32_bf16 v[144:147], a[180:183], a[120:123], v[144:147]
    buffer_load_dwordx4 v250, s[4:7], s40 offen  lds
    s_waitcnt lgkmcnt(5)
    v_mfma_f32_16x16x32_bf16 v[168:171], a[184:187], a[120:123], v[168:171]
    s_add_u32 m0, s53, 28672
    s_add_u32 s40, s40, 28672
    s_waitcnt lgkmcnt(3)
    v_mfma_f32_16x16x32_bf16 v[192:195], a[188:191], a[120:123], v[192:195]
    buffer_load_dwordx4 v250, s[4:7], s40 offen  lds
    v_mfma_f32_16x16x32_bf16 v[124:127], a[176:179], a[124:127], v[124:127]
    s_add_u32 m0, s53, 32768
    s_add_u32 s40, s40, 28672
    v_mfma_f32_16x16x32_bf16 v[148:151], a[180:183], a[124:127], v[148:151]
    buffer_load_dwordx4 v250, s[4:7], s40 offen  lds
    v_mfma_f32_16x16x32_bf16 v[172:175], a[184:187], a[124:127], v[172:175]
    s_waitcnt vmcnt(11)
    s_barrier
    v_mfma_f32_16x16x32_bf16 v[196:199], a[188:191], a[124:127], v[196:199]
    s_lshl_b32 s40, s47, 7
    s_add_u32 s40, s40, s54
    s_add_u32 m0, s53, 36864
    s_add_u32 s47, s47, 1
    s_cmp_eq_u32 s47, 7
    s_cselect_b32 s47, 0, s47
    v_mfma_f32_16x16x32_bf16 v[128:131], a[176:179], a[128:131], v[128:131]
    buffer_load_dwordx4 v250, s[4:7], s40 offen  lds
    ds_read_b128 a[96:99], v252 offset:12288
    v_mfma_f32_16x16x32_bf16 v[152:155], a[180:183], a[128:131], v[152:155]
    s_add_u32 m0, s53, 40960
    s_add_u32 s40, s40, 28672
    v_mfma_f32_16x16x32_bf16 v[176:179], a[184:187], a[128:131], v[176:179]
    buffer_load_dwordx4 v250, s[4:7], s40 offen  lds
    ds_read_b128 a[100:103], v252 offset:14336
    v_mfma_f32_16x16x32_bf16 v[200:203], a[188:191], a[128:131], v[200:203]
    ds_read_b128 a[104:107], v252 offset:16384
    s_waitcnt vmcnt(9)
    s_waitcnt lgkmcnt(5)
    v_mfma_f32_16x16x32_bf16 v[132:135], a[176:179], a[132:135], v[132:135]
    s_add_u32 m0, s53, 45056
    s_add_u32 s40, s40, 28672
    ds_read_b64_tr_b16 a[160:161], v24 offset:8192
    v_mfma_f32_16x16x32_bf16 v[156:159], a[180:183], a[132:135], v[156:159]
    buffer_load_dwordx4 v250, s[4:7], s40 offen  lds
    ds_read_b64_tr_b16 a[162:163], v24 offset:10240
    v_mfma_f32_16x16x32_bf16 v[180:183], a[184:187], a[132:135], v[180:183]
    s_lshl_b32 s41, s48, 19
    s_add_u32 s41, s41, s55
    s_add_u32 s48, s48, 1
    s_cmp_eq_u32 s48, 7
    s_cselect_b32 s48, 0, s48
    s_add_u32 m0, s49, 0
    s_add_u32 s58, s41, 0
    v_mfma_f32_16x16x32_bf16 v[204:207], a[188:191], a[132:135], v[204:207]
    buffer_load_dwordx4 v251, s[16:19], s58 offen  lds
    s_waitcnt lgkmcnt(6)
    v_mfma_f32_16x16x32_bf16 v[136:139], a[176:179], a[136:139], v[136:139]
    ds_read_b64_tr_b16 a[164:165], v25 offset:8192
    s_add_u32 m0, s49, 1024
    s_add_u32 s58, s41, 131072
    v_mfma_f32_16x16x32_bf16 v[160:163], a[180:183], a[136:139], v[160:163]
    ds_read_b64_tr_b16 a[166:167], v25 offset:10240
    buffer_load_dwordx4 v251, s[16:19], s58 offen  lds
    v_mfma_f32_16x16x32_bf16 v[184:187], a[184:187], a[136:139], v[184:187]
    ds_read_b64_tr_b16 a[168:169], v26 offset:8192
    ds_read_b64_tr_b16 a[170:171], v26 offset:10240
    v_mfma_f32_16x16x32_bf16 v[208:211], a[188:191], a[136:139], v[208:211]
    ds_read_b64_tr_b16 a[172:173], v27 offset:8192
    ds_read_b64_tr_b16 a[174:175], v27 offset:10240
    ds_read_b128 a[108:111], v252 offset:18432
    ds_read_b128 a[112:115], v252 offset:20480
    ds_read_b128 a[116:119], v252 offset:22528
    s_add_u32 m0, s49, 2048
    s_add_u32 s58, s41, 32768
    s_waitcnt lgkmcnt(14)
    v_mfma_f32_16x16x32_bf16 v[140:143], a[176:179], a[140:143], v[140:143]
    buffer_load_dwordx4 v251, s[16:19], s58 offen  lds
    v_mfma_f32_16x16x32_bf16 v[164:167], a[180:183], a[140:143], v[164:167]
    s_add_u32 m0, s49, 3072
    s_add_u32 s58, s41, 163840
    v_mfma_f32_16x16x32_bf16 v[188:191], a[184:187], a[140:143], v[188:191]
    buffer_load_dwordx4 v251, s[16:19], s58 offen  lds
    v_mfma_f32_16x16x32_bf16 v[212:215], a[188:191], a[140:143], v[212:215]
    s_waitcnt lgkmcnt(9)
    v_mfma_f32_16x16x32_bf16 v[120:123], a[160:163], a[96:99], v[120:123]
    s_add_u32 m0, s49, 4096
    s_add_u32 s58, s41, 262144
    s_waitcnt lgkmcnt(7)
    v_mfma_f32_16x16x32_bf16 v[144:147], a[164:167], a[96:99], v[144:147]
    buffer_load_dwordx4 v251, s[16:19], s58 offen  lds
    s_waitcnt lgkmcnt(5)
    v_mfma_f32_16x16x32_bf16 v[168:171], a[168:171], a[96:99], v[168:171]
    ds_read_b128 a[120:123], v253 offset:12288
    ds_read_b128 a[124:127], v253 offset:14336
    s_waitcnt lgkmcnt(5)
    v_mfma_f32_16x16x32_bf16 v[192:195], a[172:175], a[96:99], v[192:195]
    s_add_u32 m0, s49, 5120
    s_add_u32 s58, s41, 393216
    v_mfma_f32_16x16x32_bf16 v[124:127], a[160:163], a[100:103], v[124:127]
    buffer_load_dwordx4 v251, s[16:19], s58 offen  lds
    v_mfma_f32_16x16x32_bf16 v[148:151], a[164:167], a[100:103], v[148:151]
    ds_read_b128 a[128:131], v253 offset:16384
    s_waitcnt vmcnt(12)
    v_mfma_f32_16x16x32_bf16 v[172:175], a[168:171], a[100:103], v[172:175]
    s_add_u32 m0, s49, 6144
    s_add_u32 s58, s41, 294912
    v_mfma_f32_16x16x32_bf16 v[196:199], a[172:175], a[100:103], v[196:199]
    buffer_load_dwordx4 v251, s[16:19], s58 offen  lds
    v_mfma_f32_16x16x32_bf16 v[128:131], a[160:163], a[104:107], v[128:131]
    ds_read_b64_tr_b16 a[176:177], v24 offset:12288
    ds_read_b64_tr_b16 a[178:179], v24 offset:14336
    v_mfma_f32_16x16x32_bf16 v[152:155], a[164:167], a[104:107], v[152:155]
    s_add_u32 m0, s49, 7168
    s_add_u32 s58, s41, 425984
    v_mfma_f32_16x16x32_bf16 v[176:179], a[168:171], a[104:107], v[176:179]
    buffer_load_dwordx4 v251, s[16:19], s58 offen  lds
    v_mfma_f32_16x16x32_bf16 v[200:203], a[172:175], a[104:107], v[200:203]
    ds_read_b64_tr_b16 a[180:181], v25 offset:12288
    ds_read_b64_tr_b16 a[182:183], v25 offset:14336
    s_waitcnt lgkmcnt(9)
    v_mfma_f32_16x16x32_bf16 v[132:135], a[160:163], a[108:111], v[132:135]
    s_lshl_b32 s41, s48, 19
    s_add_u32 s41, s41, s55
    s_add_u32 s48, s48, 1
    s_cmp_eq_u32 s48, 7
    s_cselect_b32 s48, 0, s48
    s_add_u32 m0, s49, 8192
    s_add_u32 s58, s41, 0
    v_mfma_f32_16x16x32_bf16 v[156:159], a[164:167], a[108:111], v[156:159]
    buffer_load_dwordx4 v251, s[16:19], s58 offen  lds
    v_mfma_f32_16x16x32_bf16 v[180:183], a[168:171], a[108:111], v[180:183]
    ds_read_b64_tr_b16 a[184:185], v26 offset:12288
    ds_read_b64_tr_b16 a[186:187], v26 offset:14336
    v_mfma_f32_16x16x32_bf16 v[204:207], a[172:175], a[108:111], v[204:207]
    s_add_u32 m0, s49, 9216
    s_add_u32 s58, s41, 131072
    s_waitcnt lgkmcnt(10)
    v_mfma_f32_16x16x32_bf16 v[136:139], a[160:163], a[112:115], v[136:139]
    buffer_load_dwordx4 v251, s[16:19], s58 offen  lds
    v_mfma_f32_16x16x32_bf16 v[160:163], a[164:167], a[112:115], v[160:163]
    ds_read_b64_tr_b16 a[188:189], v27 offset:12288
    ds_read_b64_tr_b16 a[190:191], v27 offset:14336
    v_mfma_f32_16x16x32_bf16 v[184:187], a[168:171], a[112:115], v[184:187]
    s_add_u32 m0, s49, 10240
    s_add_u32 s58, s41, 32768
    v_mfma_f32_16x16x32_bf16 v[208:211], a[172:175], a[112:115], v[208:211]
    ds_read_b128 a[132:135], v253 offset:18432
    ds_read_b128 a[136:139], v253 offset:20480
    ds_read_b128 a[140:143], v253 offset:22528
    buffer_load_dwordx4 v251, s[16:19], s58 offen  lds
    s_waitcnt lgkmcnt(14)
    v_mfma_f32_16x16x32_bf16 v[140:143], a[160:163], a[116:119], v[140:143]
    v_mfma_f32_16x16x32_bf16 v[164:167], a[164:167], a[116:119], v[164:167]
    s_add_u32 m0, s49, 11264
    s_add_u32 s58, s41, 163840
    v_mfma_f32_16x16x32_bf16 v[188:191], a[168:171], a[116:119], v[188:191]
    buffer_load_dwordx4 v251, s[16:19], s58 offen  lds
    v_mfma_f32_16x16x32_bf16 v[212:215], a[172:175], a[116:119], v[212:215]
    s_waitcnt lgkmcnt(9)
    v_mfma_f32_16x16x32_bf16 v[120:123], a[176:179], a[120:123], v[120:123]
    s_waitcnt lgkmcnt(7)
    v_mfma_f32_16x16x32_bf16 v[144:147], a[180:183], a[120:123], v[144:147]
    s_waitcnt vmcnt(12)
    s_barrier
    s_waitcnt lgkmcnt(5)
    v_mfma_f32_16x16x32_bf16 v[168:171], a[184:187], a[120:123], v[168:171]
    ds_read_b128 a[96:99], v252 offset:24576
    ds_read_b128 a[100:103], v252 offset:26624
    s_waitcnt lgkmcnt(5)
    v_mfma_f32_16x16x32_bf16 v[192:195], a[188:191], a[120:123], v[192:195]
    ds_read_b128 a[104:107], v252 offset:28672
    s_waitcnt vmcnt(8)
    v_mfma_f32_16x16x32_bf16 v[124:127], a[176:179], a[124:127], v[124:127]
    ds_read_b64_tr_b16 a[160:161], v24 offset:0
    ds_read_b64_tr_b16 a[162:163], v24 offset:2048
    v_mfma_f32_16x16x32_bf16 v[148:151], a[180:183], a[124:127], v[148:151]
    s_lshl_b32 s40, s47, 7
    s_add_u32 s40, s40, s54
    s_add_u32 m0, s53, 49152
    s_add_u32 s47, s47, 1
    s_cmp_eq_u32 s47, 7
    s_cselect_b32 s47, 0, s47
    v_mfma_f32_16x16x32_bf16 v[172:175], a[184:187], a[124:127], v[172:175]
    buffer_load_dwordx4 v250, s[4:7], s40 offen  lds
    v_mfma_f32_16x16x32_bf16 v[196:199], a[188:191], a[124:127], v[196:199]
    s_add_u32 m0, s53, 53248
    s_add_u32 s40, s40, 28672
    v_mfma_f32_16x16x32_bf16 v[128:131], a[176:179], a[128:131], v[128:131]
    buffer_load_dwordx4 v250, s[4:7], s40 offen  lds
    v_mfma_f32_16x16x32_bf16 v[152:155], a[180:183], a[128:131], v[152:155]
    ds_read_b64_tr_b16 a[164:165], v25 offset:0
    ds_read_b64_tr_b16 a[166:167], v25 offset:2048
    v_mfma_f32_16x16x32_bf16 v[176:179], a[184:187], a[128:131], v[176:179]
    s_add_u32 m0, s53, 57344
    s_add_u32 s40, s40, 28672
    v_mfma_f32_16x16x32_bf16 v[200:203], a[188:191], a[128:131], v[200:203]
    buffer_load_dwordx4 v250, s[4:7], s40 offen  lds
    s_waitcnt lgkmcnt(9)
    v_mfma_f32_16x16x32_bf16 v[132:135], a[176:179], a[132:135], v[132:135]
    ds_read_b64_tr_b16 a[168:169], v26 offset:0
    ds_read_b64_tr_b16 a[170:171], v26 offset:2048
    v_mfma_f32_16x16x32_bf16 v[156:159], a[180:183], a[132:135], v[156:159]
    s_add_u32 m0, s49, 12288
    s_add_u32 s58, s41, 262144
    v_mfma_f32_16x16x32_bf16 v[180:183], a[184:187], a[132:135], v[180:183]
    buffer_load_dwordx4 v251, s[16:19], s58 offen  lds
    v_mfma_f32_16x16x32_bf16 v[204:207], a[188:191], a[132:135], v[204:207]
    s_add_u32 m0, s49, 13312
    s_add_u32 s58, s41, 393216
    s_waitcnt lgkmcnt(10)
    v_mfma_f32_16x16x32_bf16 v[136:139], a[176:179], a[136:139], v[136:139]
    buffer_load_dwordx4 v251, s[16:19], s58 offen  lds
    v_mfma_f32_16x16x32_bf16 v[160:163], a[180:183], a[136:139], v[160:163]
    ds_read_b64_tr_b16 a[172:173], v27 offset:0
    ds_read_b64_tr_b16 a[174:175], v27 offset:2048
    v_mfma_f32_16x16x32_bf16 v[184:187], a[184:187], a[136:139], v[184:187]
    s_add_u32 m0, s49, 14336
    s_add_u32 s58, s41, 294912
    v_mfma_f32_16x16x32_bf16 v[208:211], a[188:191], a[136:139], v[208:211]
    ds_read_b128 a[108:111], v252 offset:30720
    ds_read_b128 a[112:115], v252 offset:32768
    ds_read_b128 a[116:119], v252 offset:34816
    buffer_load_dwordx4 v251, s[16:19], s58 offen  lds
    s_waitcnt lgkmcnt(14)
    v_mfma_f32_16x16x32_bf16 v[140:143], a[176:179], a[140:143], v[140:143]
    v_mfma_f32_16x16x32_bf16 v[164:167], a[180:183], a[140:143], v[164:167]
    s_add_u32 m0, s49, 15360
    s_add_u32 s58, s41, 425984
    v_mfma_f32_16x16x32_bf16 v[188:191], a[184:187], a[140:143], v[188:191]
    buffer_load_dwordx4 v251, s[16:19], s58 offen  lds
    v_mfma_f32_16x16x32_bf16 v[212:215], a[188:191], a[140:143], v[212:215]
    s_waitcnt lgkmcnt(9)
    v_mfma_f32_16x16x32_bf16 v[120:123], a[160:163], a[96:99], v[120:123]
    s_waitcnt lgkmcnt(7)
    v_mfma_f32_16x16x32_bf16 v[144:147], a[164:167], a[96:99], v[144:147]
    ds_read_b128 a[120:123], v253 offset:24576
    ds_read_b128 a[124:127], v253 offset:26624
    s_waitcnt lgkmcnt(7)
    v_mfma_f32_16x16x32_bf16 v[168:171], a[168:171], a[96:99], v[168:171]
    ds_read_b128 a[128:131], v253 offset:28672
    s_waitcnt vmcnt(11)
    s_waitcnt lgkmcnt(6)
    v_mfma_f32_16x16x32_bf16 v[192:195], a[172:175], a[96:99], v[192:195]
    ds_read_b64_tr_b16 a[176:177], v24 offset:4096
    ds_read_b64_tr_b16 a[178:179], v24 offset:6144
    v_mfma_f32_16x16x32_bf16 v[124:127], a[160:163], a[100:103], v[124:127]
    ds_read_b64_tr_b16 a[180:181], v25 offset:4096
    ds_read_b64_tr_b16 a[182:183], v25 offset:6144
    v_mfma_f32_16x16x32_bf16 v[148:151], a[164:167], a[100:103], v[148:151]
    s_lshl_b32 s41, s48, 19
    s_add_u32 s41, s41, s55
    s_add_u32 s48, s48, 1
    s_cmp_eq_u32 s48, 7
    s_cselect_b32 s48, 0, s48
    s_add_u32 m0, s49, 0
    s_add_u32 s58, s41, 0
    v_mfma_f32_16x16x32_bf16 v[172:175], a[168:171], a[100:103], v[172:175]
    buffer_load_dwordx4 v251, s[16:19], s58 offen  lds
    v_mfma_f32_16x16x32_bf16 v[196:199], a[172:175], a[100:103], v[196:199]
    s_add_u32 m0, s49, 1024
    s_add_u32 s58, s41, 131072
    v_mfma_f32_16x16x32_bf16 v[128:131], a[160:163], a[104:107], v[128:131]
    buffer_load_dwordx4 v251, s[16:19], s58 offen  lds
    v_mfma_f32_16x16x32_bf16 v[152:155], a[164:167], a[104:107], v[152:155]
    ds_read_b64_tr_b16 a[184:185], v26 offset:4096
    ds_read_b64_tr_b16 a[186:187], v26 offset:6144
    v_mfma_f32_16x16x32_bf16 v[176:179], a[168:171], a[104:107], v[176:179]
    s_add_u32 m0, s49, 2048
    s_add_u32 s58, s41, 32768
    v_mfma_f32_16x16x32_bf16 v[200:203], a[172:175], a[104:107], v[200:203]
    buffer_load_dwordx4 v251, s[16:19], s58 offen  lds
    s_waitcnt lgkmcnt(11)
    v_mfma_f32_16x16x32_bf16 v[132:135], a[160:163], a[108:111], v[132:135]
    ds_read_b64_tr_b16 a[188:189], v27 offset:4096
    ds_read_b64_tr_b16 a[190:191], v27 offset:6144
    v_mfma_f32_16x16x32_bf16 v[156:159], a[164:167], a[108:111], v[156:159]
    s_add_u32 m0, s49, 3072
    s_add_u32 s58, s41, 163840
    v_mfma_f32_16x16x32_bf16 v[180:183], a[168:171], a[108:111], v[180:183]
    buffer_load_dwordx4 v251, s[16:19], s58 offen  lds
    v_mfma_f32_16x16x32_bf16 v[204:207], a[172:175], a[108:111], v[204:207]
    s_lshl_b32 s40, s47, 7
    s_add_u32 s40, s40, s54
    s_add_u32 m0, s53, 67584
    s_add_u32 s47, s47, 1
    s_cmp_eq_u32 s47, 7
    s_cselect_b32 s47, 0, s47
    s_waitcnt lgkmcnt(12)
    v_mfma_f32_16x16x32_bf16 v[136:139], a[160:163], a[112:115], v[136:139]
    buffer_load_dwordx4 v250, s[4:7], s40 offen  lds
    v_mfma_f32_16x16x32_bf16 v[160:163], a[164:167], a[112:115], v[160:163]
    ds_read_b128 a[132:135], v253 offset:30720
    ds_read_b128 a[136:139], v253 offset:32768
    v_mfma_f32_16x16x32_bf16 v[184:187], a[168:171], a[112:115], v[184:187]
    s_add_u32 m0, s53, 71680
    s_add_u32 s40, s40, 28672
    v_mfma_f32_16x16x32_bf16 v[208:211], a[172:175], a[112:115], v[208:211]
    ds_read_b128 a[140:143], v253 offset:34816
    buffer_load_dwordx4 v250, s[4:7], s40 offen  lds
    s_waitcnt lgkmcnt(14)
    v_mfma_f32_16x16x32_bf16 v[140:143], a[160:163], a[116:119], v[140:143]
    v_mfma_f32_16x16x32_bf16 v[164:167], a[164:167], a[116:119], v[164:167]
    s_add_u32 m0, s53, 75776
    s_add_u32 s40, s40, 28672
    v_mfma_f32_16x16x32_bf16 v[188:191], a[168:171], a[116:119], v[188:191]
    buffer_load_dwordx4 v250, s[4:7], s40 offen  lds
    v_mfma_f32_16x16x32_bf16 v[212:215], a[172:175], a[116:119], v[212:215]
    s_waitcnt lgkmcnt(9)
    v_mfma_f32_16x16x32_bf16 v[120:123], a[176:179], a[120:123], v[120:123]
    s_waitcnt lgkmcnt(7)
    v_mfma_f32_16x16x32_bf16 v[144:147], a[180:183], a[120:123], v[144:147]
    s_waitcnt lgkmcnt(5)
    v_mfma_f32_16x16x32_bf16 v[168:171], a[184:187], a[120:123], v[168:171]
    s_waitcnt lgkmcnt(3)
    v_mfma_f32_16x16x32_bf16 v[192:195], a[188:191], a[120:123], v[192:195]
    v_mfma_f32_16x16x32_bf16 v[124:127], a[176:179], a[124:127], v[124:127]
    v_mfma_f32_16x16x32_bf16 v[148:151], a[180:183], a[124:127], v[148:151]
    s_add_u32 m0, s49, 4096
    s_add_u32 s58, s41, 262144
    v_mfma_f32_16x16x32_bf16 v[172:175], a[184:187], a[124:127], v[172:175]
    buffer_load_dwordx4 v251, s[16:19], s58 offen  lds
    v_mfma_f32_16x16x32_bf16 v[196:199], a[188:191], a[124:127], v[196:199]
    s_add_u32 m0, s49, 5120
    s_add_u32 s58, s41, 393216
    v_mfma_f32_16x16x32_bf16 v[128:131], a[176:179], a[128:131], v[128:131]
    buffer_load_dwordx4 v251, s[16:19], s58 offen  lds
    v_mfma_f32_16x16x32_bf16 v[152:155], a[180:183], a[128:131], v[152:155]
    s_waitcnt vmcnt(13) lgkmcnt(0)
    s_barrier
    v_mfma_f32_16x16x32_bf16 v[176:179], a[184:187], a[128:131], v[176:179]
    s_add_u32 m0, s49, 6144
    s_add_u32 s58, s41, 294912
    v_mfma_f32_16x16x32_bf16 v[200:203], a[188:191], a[128:131], v[200:203]
    ds_read_b128 a[96:99], v252 offset:36864
    buffer_load_dwordx4 v251, s[16:19], s58 offen  lds
    v_mfma_f32_16x16x32_bf16 v[132:135], a[176:179], a[132:135], v[132:135]
    ds_read_b128 a[100:103], v252 offset:38912
    ds_read_b128 a[104:107], v252 offset:40960
    v_mfma_f32_16x16x32_bf16 v[156:159], a[180:183], a[132:135], v[156:159]
    s_add_u32 m0, s49, 7168
    s_add_u32 s58, s41, 425984
    v_mfma_f32_16x16x32_bf16 v[180:183], a[184:187], a[132:135], v[180:183]
    buffer_load_dwordx4 v251, s[16:19], s58 offen  lds
    ds_read_b64_tr_b16 a[160:161], v24 offset:8192
    v_mfma_f32_16x16x32_bf16 v[204:207], a[188:191], a[132:135], v[204:207]
    s_lshl_b32 s40, s47, 7
    s_add_u32 s40, s40, s54
    s_add_u32 m0, s53, 79872
    s_add_u32 s47, s47, 1
    s_cmp_eq_u32 s47, 7
    s_cselect_b32 s47, 0, s47
    v_mfma_f32_16x16x32_bf16 v[136:139], a[176:179], a[136:139], v[136:139]
    ds_read_b64_tr_b16 a[162:163], v24 offset:10240
    ds_read_b64_tr_b16 a[164:165], v25 offset:8192
    buffer_load_dwordx4 v250, s[4:7], s40 offen  lds
    v_mfma_f32_16x16x32_bf16 v[160:163], a[180:183], a[136:139], v[160:163]
    ds_read_b64_tr_b16 a[166:167], v25 offset:10240
    ds_read_b64_tr_b16 a[168:169], v26 offset:8192
    v_mfma_f32_16x16x32_bf16 v[184:187], a[184:187], a[136:139], v[184:187]
    s_add_u32 m0, s53, 83968
    s_add_u32 s40, s40, 28672
    v_mfma_f32_16x16x32_bf16 v[208:211], a[188:191], a[136:139], v[208:211]
    ds_read_b64_tr_b16 a[170:171], v26 offset:10240
    ds_read_b64_tr_b16 a[172:173], v27 offset:8192
    ds_read_b64_tr_b16 a[174:175], v27 offset:10240
    ds_read_b128 a[108:111], v252 offset:43008
    ds_read_b128 a[112:115], v252 offset:45056
    ds_read_b128 a[116:119], v252 offset:47104
    buffer_load_dwordx4 v250, s[4:7], s40 offen  lds
    v_mfma_f32_16x16x32_bf16 v[140:143], a[176:179], a[140:143], v[140:143]
    v_mfma_f32_16x16x32_bf16 v[164:167], a[180:183], a[140:143], v[164:167]
    s_add_u32 m0, s53, 88064
    s_add_u32 s40, s40, 28672
    v_mfma_f32_16x16x32_bf16 v[188:191], a[184:187], a[140:143], v[188:191]
    buffer_load_dwordx4 v250, s[4:7], s40 offen  lds
    v_mfma_f32_16x16x32_bf16 v[212:215], a[188:191], a[140:143], v[212:215]
    s_waitcnt lgkmcnt(9)
    v_mfma_f32_16x16x32_bf16 v[120:123], a[160:163], a[96:99], v[120:123]
    s_waitcnt lgkmcnt(7)
    v_mfma_f32_16x16x32_bf16 v[144:147], a[164:167], a[96:99], v[144:147]
    ds_read_b128 a[120:123], v253 offset:36864
    ds_read_b128 a[124:127], v253 offset:38912
    s_waitcnt lgkmcnt(7)
    v_mfma_f32_16x16x32_bf16 v[168:171], a[168:171], a[96:99], v[168:171]
    ds_read_b128 a[128:131], v253 offset:40960
    s_waitcnt vmcnt(14)
    s_waitcnt lgkmcnt(6)
    v_mfma_f32_16x16x32_bf16 v[192:195], a[172:175], a[96:99], v[192:195]
    ds_read_b64_tr_b16 a[176:177], v24 offset:12288
    ds_read_b64_tr_b16 a[178:179], v24 offset:14336
    v_mfma_f32_16x16x32_bf16 v[124:127], a[160:163], a[100:103], v[124:127]
    ds_read_b64_tr_b16 a[180:181], v25 offset:12288
    ds_read_b64_tr_b16 a[182:183], v25 offset:14336
    v_mfma_f32_16x16x32_bf16 v[148:151], a[164:167], a[100:103], v[148:151]
    s_lshl_b32 s41, s48, 19
    s_add_u32 s41, s41, s55
    s_add_u32 s48, s48, 1
    s_cmp_eq_u32 s48, 7
    s_cselect_b32 s48, 0, s48
    s_add_u32 m0, s49, 8192
    s_add_u32 s58, s41, 0
    v_mfma_f32_16x16x32_bf16 v[172:175], a[168:171], a[100:103], v[172:175]
    buffer_load_dwordx4 v251, s[16:19], s58 offen  lds
    v_mfma_f32_16x16x32_bf16 v[196:199], a[172:175], a[100:103], v[196:199]
    ds_read_b64_tr_b16 a[184:185], v26 offset:12288
    ds_read_b64_tr_b16 a[186:187], v26 offset:14336
    v_mfma_f32_16x16x32_bf16 v[128:131], a[160:163], a[104:107], v[128:131]
    s_add_u32 m0, s49, 9216
    s_add_u32 s58, s41, 131072
    v_mfma_f32_16x16x32_bf16 v[152:155], a[164:167], a[104:107], v[152:155]
    buffer_load_dwordx4 v251, s[16:19], s58 offen  lds
    v_mfma_f32_16x16x32_bf16 v[176:179], a[168:171], a[104:107], v[176:179]
    ds_read_b64_tr_b16 a[188:189], v27 offset:12288
    ds_read_b64_tr_b16 a[190:191], v27 offset:14336
    v_mfma_f32_16x16x32_bf16 v[200:203], a[172:175], a[104:107], v[200:203]
    ds_read_b128 a[132:135], v253 offset:43008
    s_waitcnt lgkmcnt(14)
    v_mfma_f32_16x16x32_bf16 v[132:135], a[160:163], a[108:111], v[132:135]
    s_add_u32 m0, s49, 10240
    s_add_u32 s58, s41, 32768
    v_mfma_f32_16x16x32_bf16 v[156:159], a[164:167], a[108:111], v[156:159]
    buffer_load_dwordx4 v251, s[16:19], s58 offen  lds
    v_mfma_f32_16x16x32_bf16 v[180:183], a[168:171], a[108:111], v[180:183]
    ds_read_b128 a[136:139], v253 offset:45056
    ds_read_b128 a[140:143], v253 offset:47104
    v_mfma_f32_16x16x32_bf16 v[204:207], a[172:175], a[108:111], v[204:207]
    s_waitcnt lgkmcnt(15)
    v_mfma_f32_16x16x32_bf16 v[136:139], a[160:163], a[112:115], v[136:139]
    s_add_u32 m0, s49, 11264
    s_add_u32 s58, s41, 163840
    v_mfma_f32_16x16x32_bf16 v[160:163], a[164:167], a[112:115], v[160:163]
    buffer_load_dwordx4 v251, s[16:19], s58 offen  lds
    v_mfma_f32_16x16x32_bf16 v[184:187], a[168:171], a[112:115], v[184:187]
    v_mfma_f32_16x16x32_bf16 v[208:211], a[172:175], a[112:115], v[208:211]
    s_waitcnt lgkmcnt(14)
    v_mfma_f32_16x16x32_bf16 v[140:143], a[160:163], a[116:119], v[140:143]
    s_lshl_b32 s3, s29, 4
    s_add_u32 s3, s3, s35
    v_mfma_f32_16x16x32_bf16 v[164:167], a[164:167], a[116:119], v[164:167]
    buffer_store_dword v116, v244, s[88:91], s3 offen sc1
    v_mfma_f32_16x16x32_bf16 v[188:191], a[168:171], a[116:119], v[188:191]
    v_mfma_f32_16x16x32_bf16 v[212:215], a[172:175], a[116:119], v[212:215]
    s_waitcnt lgkmcnt(9)
    v_mfma_f32_16x16x32_bf16 v[120:123], a[176:179], a[120:123], v[120:123]
    s_waitcnt lgkmcnt(7)
    v_mfma_f32_16x16x32_bf16 v[144:147], a[180:183], a[120:123], v[144:147]
    v_add_u32 v252, 49152, v252
    v_add_u32 v253, 49152, v253
    s_waitcnt lgkmcnt(5)
    v_mfma_f32_16x16x32_bf16 v[168:171], a[184:187], a[120:123], v[168:171]
    ds_read_b128 a[96:99], v252 offset:0
    ds_read_b128 a[100:103], v252 offset:2048
    s_waitcnt lgkmcnt(5)
    v_mfma_f32_16x16x32_bf16 v[192:195], a[188:191], a[120:123], v[192:195]
    ds_read_b128 a[104:107], v252 offset:4096
    s_waitcnt vmcnt(15)
    v_mfma_f32_16x16x32_bf16 v[124:127], a[176:179], a[124:127], v[124:127]
    ds_read_b64_tr_b16 a[160:161], v24 offset:0
    ds_read_b64_tr_b16 a[162:163], v24 offset:2048
    v_mfma_f32_16x16x32_bf16 v[148:151], a[180:183], a[124:127], v[148:151]
    s_add_u32 m0, s49, 12288
    s_add_u32 s58, s41, 262144
    v_mfma_f32_16x16x32_bf16 v[172:175], a[184:187], a[124:127], v[172:175]
    buffer_load_dwordx4 v251, s[16:19], s58 offen  lds
    v_mfma_f32_16x16x32_bf16 v[196:199], a[188:191], a[124:127], v[196:199]
    ds_read_b64_tr_b16 a[164:165], v25 offset:0
    ds_read_b64_tr_b16 a[166:167], v25 offset:2048
    v_mfma_f32_16x16x32_bf16 v[128:131], a[176:179], a[128:131], v[128:131]
    ds_read_b64_tr_b16 a[168:169], v26 offset:0
    ds_read_b64_tr_b16 a[170:171], v26 offset:2048
    v_mfma_f32_16x16x32_bf16 v[152:155], a[180:183], a[128:131], v[152:155]
    s_add_u32 m0, s49, 13312
    s_add_u32 s58, s41, 393216
    v_mfma_f32_16x16x32_bf16 v[176:179], a[184:187], a[128:131], v[176:179]
    buffer_load_dwordx4 v251, s[16:19], s58 offen  lds
    v_mfma_f32_16x16x32_bf16 v[200:203], a[188:191], a[128:131], v[200:203]
    ds_read_b64_tr_b16 a[172:173], v27 offset:0
    ds_read_b64_tr_b16 a[174:175], v27 offset:2048
    s_waitcnt lgkmcnt(13)
    v_mfma_f32_16x16x32_bf16 v[132:135], a[176:179], a[132:135], v[132:135]
    ds_read_b128 a[108:111], v252 offset:6144
    ds_read_b128 a[112:115], v252 offset:8192
    v_mfma_f32_16x16x32_bf16 v[156:159], a[180:183], a[132:135], v[156:159]
    ds_read_b128 a[116:119], v252 offset:10240
    v_mfma_f32_16x16x32_bf16 v[180:183], a[184:187], a[132:135], v[180:183]
    s_add_u32 m0, s49, 14336
    s_add_u32 s58, s41, 294912
    v_mfma_f32_16x16x32_bf16 v[204:207], a[188:191], a[132:135], v[204:207]
    buffer_load_dwordx4 v251, s[16:19], s58 offen  lds
    s_waitcnt lgkmcnt(15)
    v_mfma_f32_16x16x32_bf16 v[136:139], a[176:179], a[136:139], v[136:139]
    v_mfma_f32_16x16x32_bf16 v[160:163], a[180:183], a[136:139], v[160:163]
    v_mfma_f32_16x16x32_bf16 v[184:187], a[184:187], a[136:139], v[184:187]
    v_mfma_f32_16x16x32_bf16 v[208:211], a[188:191], a[136:139], v[208:211]
    s_add_u32 m0, s49, 15360
    s_add_u32 s58, s41, 425984
    s_waitcnt lgkmcnt(14)
    v_mfma_f32_16x16x32_bf16 v[140:143], a[176:179], a[140:143], v[140:143]
    buffer_load_dwordx4 v251, s[16:19], s58 offen  lds
    v_mfma_f32_16x16x32_bf16 v[164:167], a[180:183], a[140:143], v[164:167]
    v_mfma_f32_16x16x32_bf16 v[188:191], a[184:187], a[140:143], v[188:191]
    v_mfma_f32_16x16x32_bf16 v[212:215], a[188:191], a[140:143], v[212:215]
    s_waitcnt lgkmcnt(9)
    v_mfma_f32_16x16x32_bf16 v[120:123], a[160:163], a[96:99], v[120:123]
    s_waitcnt lgkmcnt(7)
    v_mfma_f32_16x16x32_bf16 v[144:147], a[164:167], a[96:99], v[144:147]
    ds_read_b128 a[120:123], v253 offset:0
    ds_read_b128 a[124:127], v253 offset:2048
    s_waitcnt lgkmcnt(7)
    v_mfma_f32_16x16x32_bf16 v[168:171], a[168:171], a[96:99], v[168:171]
    ds_read_b128 a[128:131], v253 offset:4096
    s_waitcnt vmcnt(12)
    s_waitcnt lgkmcnt(6)
    v_mfma_f32_16x16x32_bf16 v[192:195], a[172:175], a[96:99], v[192:195]
    ds_read_b64_tr_b16 a[176:177], v24 offset:4096
    ds_read_b64_tr_b16 a[178:179], v24 offset:6144
    v_mfma_f32_16x16x32_bf16 v[124:127], a[160:163], a[100:103], v[124:127]
    ds_read_b64_tr_b16 a[180:181], v25 offset:4096
    ds_read_b64_tr_b16 a[182:183], v25 offset:6144
    v_mfma_f32_16x16x32_bf16 v[148:151], a[164:167], a[100:103], v[148:151]
    s_lshl_b32 s41, s48, 19
    s_add_u32 s41, s41, s55
    s_add_u32 s48, s48, 1
    s_cmp_eq_u32 s48, 7
    s_cselect_b32 s48, 0, s48
    s_add_u32 m0, s49, 0
    s_add_u32 s58, s41, 0
    v_mfma_f32_16x16x32_bf16 v[172:175], a[168:171], a[100:103], v[172:175]
    buffer_load_dwordx4 v251, s[16:19], s58 offen  lds
    v_mfma_f32_16x16x32_bf16 v[196:199], a[172:175], a[100:103], v[196:199]
    ds_read_b64_tr_b16 a[184:185], v26 offset:4096
    ds_read_b64_tr_b16 a[186:187], v26 offset:6144
    v_mfma_f32_16x16x32_bf16 v[128:131], a[160:163], a[104:107], v[128:131]
    ds_read_b64_tr_b16 a[188:189], v27 offset:4096
    v_mfma_f32_16x16x32_bf16 v[152:155], a[164:167], a[104:107], v[152:155]
    s_add_u32 m0, s49, 1024
    s_add_u32 s58, s41, 131072
    v_mfma_f32_16x16x32_bf16 v[176:179], a[168:171], a[104:107], v[176:179]
    buffer_load_dwordx4 v251, s[16:19], s58 offen  lds
    v_mfma_f32_16x16x32_bf16 v[200:203], a[172:175], a[104:107], v[200:203]
    ds_read_b64_tr_b16 a[190:191], v27 offset:6144
    ds_read_b128 a[132:135], v253 offset:6144
    s_waitcnt lgkmcnt(14)
    v_mfma_f32_16x16x32_bf16 v[132:135], a[160:163], a[108:111], v[132:135]
    ds_read_b128 a[136:139], v253 offset:8192
    v_mfma_f32_16x16x32_bf16 v[156:159], a[164:167], a[108:111], v[156:159]
    ds_read_b128 a[140:143], v253 offset:10240
    v_mfma_f32_16x16x32_bf16 v[180:183], a[168:171], a[108:111], v[180:183]
    s_add_u32 m0, s49, 2048
    s_add_u32 s58, s41, 32768
    v_mfma_f32_16x16x32_bf16 v[204:207], a[172:175], a[108:111], v[204:207]
    buffer_load_dwordx4 v251, s[16:19], s58 offen  lds
    s_waitcnt lgkmcnt(15)
    v_mfma_f32_16x16x32_bf16 v[136:139], a[160:163], a[112:115], v[136:139]
    v_mfma_f32_16x16x32_bf16 v[160:163], a[164:167], a[112:115], v[160:163]
    v_mfma_f32_16x16x32_bf16 v[184:187], a[168:171], a[112:115], v[184:187]
    v_mfma_f32_16x16x32_bf16 v[208:211], a[172:175], a[112:115], v[208:211]
    s_add_u32 m0, s49, 3072
    s_add_u32 s58, s41, 163840
    s_waitcnt lgkmcnt(14)
    v_mfma_f32_16x16x32_bf16 v[140:143], a[160:163], a[116:119], v[140:143]
    buffer_load_dwordx4 v251, s[16:19], s58 offen  lds
    v_mfma_f32_16x16x32_bf16 v[164:167], a[164:167], a[116:119], v[164:167]
    v_mfma_f32_16x16x32_bf16 v[188:191], a[168:171], a[116:119], v[188:191]
    v_mfma_f32_16x16x32_bf16 v[212:215], a[172:175], a[116:119], v[212:215]
    s_waitcnt lgkmcnt(9)
    v_mfma_f32_16x16x32_bf16 v[120:123], a[176:179], a[120:123], v[120:123]
    s_waitcnt lgkmcnt(7)
    v_mfma_f32_16x16x32_bf16 v[144:147], a[180:183], a[120:123], v[144:147]
    s_waitcnt lgkmcnt(5)
    v_mfma_f32_16x16x32_bf16 v[168:171], a[184:187], a[120:123], v[168:171]
    s_waitcnt lgkmcnt(3)
    v_mfma_f32_16x16x32_bf16 v[192:195], a[188:191], a[120:123], v[192:195]
    v_mfma_f32_16x16x32_bf16 v[124:127], a[176:179], a[124:127], v[124:127]
    v_mfma_f32_16x16x32_bf16 v[148:151], a[180:183], a[124:127], v[148:151]
    s_add_u32 m0, s49, 4096
    s_add_u32 s58, s41, 262144
    v_mfma_f32_16x16x32_bf16 v[172:175], a[184:187], a[124:127], v[172:175]
    buffer_load_dwordx4 v251, s[16:19], s58 offen  lds
    v_mfma_f32_16x16x32_bf16 v[196:199], a[188:191], a[124:127], v[196:199]
    s_waitcnt vmcnt(14) lgkmcnt(0)
    s_barrier
    v_mfma_f32_16x16x32_bf16 v[128:131], a[176:179], a[128:131], v[128:131]
    s_add_u32 m0, s49, 5120
    s_add_u32 s58, s41, 393216
    v_mfma_f32_16x16x32_bf16 v[152:155], a[180:183], a[128:131], v[152:155]
    buffer_load_dwordx4 v251, s[16:19], s58 offen  lds
    v_mfma_f32_16x16x32_bf16 v[176:179], a[184:187], a[128:131], v[176:179]
    ds_read_b128 a[96:99], v252 offset:18432
    ds_read_b128 a[100:103], v252 offset:20480
    v_mfma_f32_16x16x32_bf16 v[200:203], a[188:191], a[128:131], v[200:203]
    s_add_u32 m0, s49, 6144
    s_add_u32 s58, s41, 294912
    v_mfma_f32_16x16x32_bf16 v[132:135], a[176:179], a[132:135], v[132:135]
    buffer_load_dwordx4 v251, s[16:19], s58 offen  lds
    v_mfma_f32_16x16x32_bf16 v[156:159], a[180:183], a[132:135], v[156:159]
    ds_read_b128 a[104:107], v252 offset:22528
    s_waitcnt vmcnt(12)
    v_mfma_f32_16x16x32_bf16 v[180:183], a[184:187], a[132:135], v[180:183]
    s_add_u32 m0, s49, 7168
    s_add_u32 s58, s41, 425984
    v_mfma_f32_16x16x32_bf16 v[204:207], a[188:191], a[132:135], v[204:207]
    ds_read_b64_tr_b16 a[160:161], v24 offset:8192
    buffer_load_dwordx4 v251, s[16:19], s58 offen  lds
    v_mfma_f32_16x16x32_bf16 v[136:139], a[176:179], a[136:139], v[136:139]
    ds_read_b64_tr_b16 a[162:163], v24 offset:10240
    ds_read_b64_tr_b16 a[164:165], v25 offset:8192
    v_mfma_f32_16x16x32_bf16 v[160:163], a[180:183], a[136:139], v[160:163]
    ds_read_b64_tr_b16 a[166:167], v25 offset:10240
    s_add_u32 m0, s38, 0
    v_mfma_f32_16x16x32_bf16 v[184:187], a[184:187], a[136:139], v[184:187]
    ds_read_b64_tr_b16 a[168:169], v26 offset:8192
    buffer_load_dwordx4 v2, s[8:11], s32 offen nt lds
    v_mfma_f32_16x16x32_bf16 v[208:211], a[188:191], a[136:139], v[208:211]
    ds_read_b64_tr_b16 a[170:171], v26 offset:10240
    ds_read_b64_tr_b16 a[172:173], v27 offset:8192
    ds_read_b64_tr_b16 a[174:175], v27 offset:10240
    ds_read_b128 a[108:111], v252 offset:24576
    ds_read_b128 a[112:115], v252 offset:26624
    ds_read_b128 a[116:119], v252 offset:28672
    v_mfma_f32_16x16x32_bf16 v[140:143], a[176:179], a[140:143], v[140:143]
    s_add_u32 m0, s38, 2176
    v_mfma_f32_16x16x32_bf16 v[164:167], a[180:183], a[140:143], v[164:167]
    buffer_load_dwordx4 v2, s[8:11], s32 offen offset:2048 nt lds
    v_mfma_f32_16x16x32_bf16 v[188:191], a[184:187], a[140:143], v[188:191]
    v_mfma_f32_16x16x32_bf16 v[212:215], a[188:191], a[140:143], v[212:215]
    s_waitcnt lgkmcnt(9)
    v_mfma_f32_16x16x32_bf16 v[120:123], a[160:163], a[96:99], v[120:123]
    s_waitcnt lgkmcnt(7)
    v_mfma_f32_16x16x32_bf16 v[144:147], a[164:167], a[96:99], v[144:147]
    ds_read_b128 a[120:123], v253 offset:18432
    ds_read_b128 a[124:127], v253 offset:20480
    s_waitcnt lgkmcnt(7)
    v_mfma_f32_16x16x32_bf16 v[168:171], a[168:171], a[96:99], v[168:171]
    ds_read_b128 a[128:131], v253 offset:22528
    s_waitcnt vmcnt(10)
    s_waitcnt lgkmcnt(6)
    v_mfma_f32_16x16x32_bf16 v[192:195], a[172:175], a[96:99], v[192:195]
    ds_read_b64_tr_b16 a[176:177], v24 offset:12288
    ds_read_b64_tr_b16 a[178:179], v24 offset:14336
    v_mfma_f32_16x16x32_bf16 v[124:127], a[160:163], a[100:103], v[124:127]
    ds_read_b64_tr_b16 a[180:181], v25 offset:12288
    ds_read_b64_tr_b16 a[182:183], v25 offset:14336
    v_mfma_f32_16x16x32_bf16 v[148:151], a[164:167], a[100:103], v[148:151]
    s_add_u32 m0, s38, 8448
    ds_read_b64_tr_b16 a[184:185], v26 offset:12288
    v_mfma_f32_16x16x32_bf16 v[172:175], a[168:171], a[100:103], v[172:175]
    buffer_load_dwordx4 v3, s[8:11], s32 offen nt lds
    v_mfma_f32_16x16x32_bf16 v[196:199], a[172:175], a[100:103], v[196:199]
    ds_read_b64_tr_b16 a[186:187], v26 offset:14336
    v_mfma_f32_16x16x32_bf16 v[128:131], a[160:163], a[104:107], v[128:131]
    s_add_u32 m0, s38, 10624
    ds_read_b64_tr_b16 a[188:189], v27 offset:12288
    v_mfma_f32_16x16x32_bf16 v[152:155], a[164:167], a[104:107], v[152:155]
    buffer_load_dwordx4 v3, s[8:11], s32 offen offset:2048 nt lds
    v_mfma_f32_16x16x32_bf16 v[176:179], a[168:171], a[104:107], v[176:179]
    ds_read_b64_tr_b16 a[190:191], v27 offset:14336
    v_mfma_f32_16x16x32_bf16 v[200:203], a[172:175], a[104:107], v[200:203]
    s_add_u32 m0, s38, 16896
    ds_read_b128 a[132:135], v253 offset:24576
    s_waitcnt lgkmcnt(14)
    v_mfma_f32_16x16x32_bf16 v[132:135], a[160:163], a[108:111], v[132:135]
    buffer_load_dwordx4 v4, s[8:11], s32 offen nt lds
    v_mfma_f32_16x16x32_bf16 v[156:159], a[164:167], a[108:111], v[156:159]
    ds_read_b128 a[136:139], v253 offset:26624
    ds_read_b128 a[140:143], v253 offset:28672
    v_mfma_f32_16x16x32_bf16 v[180:183], a[168:171], a[108:111], v[180:183]
    s_add_u32 m0, s38, 19072
    v_mfma_f32_16x16x32_bf16 v[204:207], a[172:175], a[108:111], v[204:207]
    buffer_load_dwordx4 v4, s[8:11], s32 offen offset:2048 nt lds
    s_waitcnt lgkmcnt(15)
    v_mfma_f32_16x16x32_bf16 v[136:139], a[160:163], a[112:115], v[136:139]
    v_mfma_f32_16x16x32_bf16 v[160:163], a[164:167], a[112:115], v[160:163]
    s_add_u32 m0, s38, 25344
    v_mfma_f32_16x16x32_bf16 v[184:187], a[168:171], a[112:115], v[184:187]
    buffer_load_dwordx4 v5, s[8:11], s32 offen nt lds
    v_mfma_f32_16x16x32_bf16 v[208:211], a[172:175], a[112:115], v[208:211]
    s_waitcnt lgkmcnt(14)
    v_mfma_f32_16x16x32_bf16 v[140:143], a[160:163], a[116:119], v[140:143]
    s_add_u32 m0, s38, 27520
    v_mfma_f32_16x16x32_bf16 v[164:167], a[164:167], a[116:119], v[164:167]
    buffer_load_dwordx4 v5, s[8:11], s32 offen offset:2048 nt lds
    v_mfma_f32_16x16x32_bf16 v[188:191], a[168:171], a[116:119], v[188:191]
    v_mfma_f32_16x16x32_bf16 v[212:215], a[172:175], a[116:119], v[212:215]
    s_add_u32 s32, s32, 32768
    s_waitcnt lgkmcnt(9)
    v_mfma_f32_16x16x32_bf16 v[120:123], a[176:179], a[120:123], v[120:123]
    s_waitcnt lgkmcnt(7)
    v_mfma_f32_16x16x32_bf16 v[144:147], a[180:183], a[120:123], v[144:147]
    ds_read_b128 a[96:99], v252 offset:30720
    ds_read_b128 a[100:103], v252 offset:32768
    s_waitcnt lgkmcnt(7)
    v_mfma_f32_16x16x32_bf16 v[168:171], a[184:187], a[120:123], v[168:171]
    ds_read_b128 a[104:107], v252 offset:34816
    s_waitcnt vmcnt(12)
    s_waitcnt lgkmcnt(6)
    v_mfma_f32_16x16x32_bf16 v[192:195], a[188:191], a[120:123], v[192:195]
    ds_read_b64_tr_b16 a[160:161], v24 offset:0
    ds_read_b64_tr_b16 a[162:163], v24 offset:2048
    v_mfma_f32_16x16x32_bf16 v[124:127], a[176:179], a[124:127], v[124:127]
    ds_read_b64_tr_b16 a[164:165], v25 offset:0
    ds_read_b64_tr_b16 a[166:167], v25 offset:2048
    v_mfma_f32_16x16x32_bf16 v[148:151], a[180:183], a[124:127], v[148:151]
    s_add_u32 m0, s38, 33792
    ds_read_b64_tr_b16 a[168:169], v26 offset:0
    v_mfma_f32_16x16x32_bf16 v[172:175], a[184:187], a[124:127], v[172:175]
    buffer_load_dwordx4 v2, s[8:11], s32 offen nt lds
    v_mfma_f32_16x16x32_bf16 v[196:199], a[188:191], a[124:127], v[196:199]
    ds_read_b64_tr_b16 a[170:171], v26 offset:2048
    v_mfma_f32_16x16x32_bf16 v[128:131], a[176:179], a[128:131], v[128:131]
    ds_read_b64_tr_b16 a[172:173], v27 offset:0
    v_mfma_f32_16x16x32_bf16 v[152:155], a[180:183], a[128:131], v[152:155]
    s_add_u32 m0, s38, 35968
    ds_read_b64_tr_b16 a[174:175], v27 offset:2048
    v_mfma_f32_16x16x32_bf16 v[176:179], a[184:187], a[128:131], v[176:179]
    buffer_load_dwordx4 v2, s[8:11], s32 offen offset:2048 nt lds
    v_mfma_f32_16x16x32_bf16 v[200:203], a[188:191], a[128:131], v[200:203]
    ds_read_b128 a[108:111], v252 offset:36864
    s_waitcnt lgkmcnt(14)
    v_mfma_f32_16x16x32_bf16 v[132:135], a[176:179], a[132:135], v[132:135]
    ds_read_b128 a[112:115], v252 offset:38912
    v_mfma_f32_16x16x32_bf16 v[156:159], a[180:183], a[132:135], v[156:159]
    ds_read_b128 a[116:119], v252 offset:40960
    v_mfma_f32_16x16x32_bf16 v[180:183], a[184:187], a[132:135], v[180:183]
    s_add_u32 m0, s38, 42240
    v_mfma_f32_16x16x32_bf16 v[204:207], a[188:191], a[132:135], v[204:207]
    buffer_load_dwordx4 v3, s[8:11], s32 offen nt lds
    s_waitcnt lgkmcnt(15)
    v_mfma_f32_16x16x32_bf16 v[136:139], a[176:179], a[136:139], v[136:139]
    v_mfma_f32_16x16x32_bf16 v[160:163], a[180:183], a[136:139], v[160:163]
    v_mfma_f32_16x16x32_bf16 v[184:187], a[184:187], a[136:139], v[184:187]
    v_mfma_f32_16x16x32_bf16 v[208:211], a[188:191], a[136:139], v[208:211]
    s_add_u32 m0, s38, 44416
    s_waitcnt lgkmcnt(14)
    v_mfma_f32_16x16x32_bf16 v[140:143], a[176:179], a[140:143], v[140:143]
    buffer_load_dwordx4 v3, s[8:11], s32 offen offset:2048 nt lds
    v_mfma_f32_16x16x32_bf16 v[164:167], a[180:183], a[140:143], v[164:167]
    v_mfma_f32_16x16x32_bf16 v[188:191], a[184:187], a[140:143], v[188:191]
    v_mfma_f32_16x16x32_bf16 v[212:215], a[188:191], a[140:143], v[212:215]
    s_waitcnt lgkmcnt(9)
    v_mfma_f32_16x16x32_bf16 v[120:123], a[160:163], a[96:99], v[120:123]
    s_waitcnt lgkmcnt(7)
    v_mfma_f32_16x16x32_bf16 v[144:147], a[164:167], a[96:99], v[144:147]
    ds_read_b128 a[120:123], v253 offset:30720
    ds_read_b128 a[124:127], v253 offset:32768
    s_waitcnt lgkmcnt(7)
    v_mfma_f32_16x16x32_bf16 v[168:171], a[168:171], a[96:99], v[168:171]
    ds_read_b128 a[128:131], v253 offset:34816
    s_waitcnt vmcnt(12)
    s_waitcnt lgkmcnt(6)
    v_mfma_f32_16x16x32_bf16 v[192:195], a[172:175], a[96:99], v[192:195]
    ds_read_b64_tr_b16 a[176:177], v24 offset:4096
    ds_read_b64_tr_b16 a[178:179], v24 offset:6144
    v_mfma_f32_16x16x32_bf16 v[124:127], a[160:163], a[100:103], v[124:127]
    ds_read_b64_tr_b16 a[180:181], v25 offset:4096
    ds_read_b64_tr_b16 a[182:183], v25 offset:6144
    v_mfma_f32_16x16x32_bf16 v[148:151], a[164:167], a[100:103], v[148:151]
    s_add_u32 m0, s38, 50688
    ds_read_b64_tr_b16 a[184:185], v26 offset:4096
    v_mfma_f32_16x16x32_bf16 v[172:175], a[168:171], a[100:103], v[172:175]
    buffer_load_dwordx4 v4, s[8:11], s32 offen nt lds
    v_mfma_f32_16x16x32_bf16 v[196:199], a[172:175], a[100:103], v[196:199]
    ds_read_b64_tr_b16 a[186:187], v26 offset:6144
    ds_read_b64_tr_b16 a[188:189], v27 offset:4096
    v_mfma_f32_16x16x32_bf16 v[128:131], a[160:163], a[104:107], v[128:131]
    ds_read_b64_tr_b16 a[190:191], v27 offset:6144
    ds_read_b128 a[132:135], v253 offset:36864
    v_mfma_f32_16x16x32_bf16 v[152:155], a[164:167], a[104:107], v[152:155]
    s_add_u32 m0, s38, 52864
    ds_read_b128 a[136:139], v253 offset:38912
    v_mfma_f32_16x16x32_bf16 v[176:179], a[168:171], a[104:107], v[176:179]
    buffer_load_dwordx4 v4, s[8:11], s32 offen offset:2048 nt lds
    v_mfma_f32_16x16x32_bf16 v[200:203], a[172:175], a[104:107], v[200:203]
    ds_read_b128 a[140:143], v253 offset:40960
    s_waitcnt lgkmcnt(15)
    v_mfma_f32_16x16x32_bf16 v[132:135], a[160:163], a[108:111], v[132:135]
    v_mfma_f32_16x16x32_bf16 v[156:159], a[164:167], a[108:111], v[156:159]
    v_mfma_f32_16x16x32_bf16 v[180:183], a[168:171], a[108:111], v[180:183]
    s_add_u32 m0, s38, 59136
    v_mfma_f32_16x16x32_bf16 v[204:207], a[172:175], a[108:111], v[204:207]
    buffer_load_dwordx4 v5, s[8:11], s32 offen nt lds
    v_mfma_f32_16x16x32_bf16 v[136:139], a[160:163], a[112:115], v[136:139]
    v_mfma_f32_16x16x32_bf16 v[160:163], a[164:167], a[112:115], v[160:163]
    v_mfma_f32_16x16x32_bf16 v[184:187], a[168:171], a[112:115], v[184:187]
    v_mfma_f32_16x16x32_bf16 v[208:211], a[172:175], a[112:115], v[208:211]
    s_add_u32 m0, s38, 61312
    s_waitcnt lgkmcnt(14)
    v_mfma_f32_16x16x32_bf16 v[140:143], a[160:163], a[116:119], v[140:143]
    buffer_load_dwordx4 v5, s[8:11], s32 offen offset:2048 nt lds
    v_mfma_f32_16x16x32_bf16 v[164:167], a[164:167], a[116:119], v[164:167]
    v_mfma_f32_16x16x32_bf16 v[188:191], a[168:171], a[116:119], v[188:191]
    v_mfma_f32_16x16x32_bf16 v[212:215], a[172:175], a[116:119], v[212:215]
    s_add_u32 s32, s32, 32768
    s_waitcnt lgkmcnt(9)
    v_mfma_f32_16x16x32_bf16 v[120:123], a[176:179], a[120:123], v[120:123]
    s_waitcnt lgkmcnt(7)
    v_mfma_f32_16x16x32_bf16 v[144:147], a[180:183], a[120:123], v[144:147]
    s_waitcnt lgkmcnt(0)
    s_barrier
    v_mfma_f32_16x16x32_bf16 v[168:171], a[184:187], a[120:123], v[168:171]
    v_mfma_f32_16x16x32_bf16 v[192:195], a[188:191], a[120:123], v[192:195]
    s_add_u32 m0, s38, 67584
    v_mfma_f32_16x16x32_bf16 v[124:127], a[176:179], a[124:127], v[124:127]
    buffer_load_dwordx4 v2, s[12:15], s33 offen nt lds
    v_mfma_f32_16x16x32_bf16 v[148:151], a[180:183], a[124:127], v[148:151]
    v_mfma_f32_16x16x32_bf16 v[172:175], a[184:187], a[124:127], v[172:175]
    v_cvt_pk_bf16_f32 v32, v120, v121
    v_cvt_pk_bf16_f32 v33, v122, v123
    ds_write_b64 v248, v[32:33] offset:0
    v_mfma_f32_16x16x32_bf16 v[196:199], a[188:191], a[124:127], v[196:199]
    v_cvt_pk_bf16_f32 v34, v144, v145
    v_cvt_pk_bf16_f32 v35, v146, v147
    ds_write_b64 v248, v[34:35] offset:512
    v_mfma_f32_16x16x32_bf16 v[128:131], a[176:179], a[128:131], v[128:131]
    s_add_u32 m0, s38, 69760
    v_cvt_pk_bf16_f32 v36, v168, v169
    v_cvt_pk_bf16_f32 v37, v170, v171
    v_mfma_f32_16x16x32_bf16 v[152:155], a[180:183], a[128:131], v[152:155]
    ds_write_b64 v248, v[36:37] offset:6144
    v_cvt_pk_bf16_f32 v38, v192, v193
    v_cvt_pk_bf16_f32 v39, v194, v195
    buffer_load_dwordx4 v2, s[12:15], s33 offen offset:2048 nt lds
    ds_write_b64 v248, v[38:39] offset:6656
    v_mfma_f32_16x16x32_bf16 v[176:179], a[184:187], a[128:131], v[176:179]
    v_cvt_pk_bf16_f32 v40, v124, v125
    v_cvt_pk_bf16_f32 v41, v126, v127
    v_mfma_f32_16x16x32_bf16 v[200:203], a[188:191], a[128:131], v[200:203]
    ds_write_b64 v248, v[40:41] offset:1024
    v_cvt_pk_bf16_f32 v42, v148, v149
    v_cvt_pk_bf16_f32 v43, v150, v151
    v_mfma_f32_16x16x32_bf16 v[132:135], a[176:179], a[132:135], v[132:135]
    ds_write_b64 v248, v[42:43] offset:1536
    v_cvt_pk_bf16_f32 v44, v172, v173
    v_cvt_pk_bf16_f32 v45, v174, v175
    v_mfma_f32_16x16x32_bf16 v[156:159], a[180:183], a[132:135], v[156:159]
    ds_write_b64 v248, v[44:45] offset:7168
    v_cvt_pk_bf16_f32 v46, v196, v197
    v_cvt_pk_bf16_f32 v47, v198, v199
    ds_write_b64 v248, v[46:47] offset:7680
    s_add_u32 m0, s38, 76032
    v_mfma_f32_16x16x32_bf16 v[180:183], a[184:187], a[132:135], v[180:183]
    buffer_load_dwordx4 v3, s[12:15], s33 offen nt lds
    v_cvt_pk_bf16_f32 v48, v128, v129
    v_cvt_pk_bf16_f32 v49, v130, v131
    v_mfma_f32_16x16x32_bf16 v[204:207], a[188:191], a[132:135], v[204:207]
    ds_write_b64 v248, v[48:49] offset:2048
    v_cvt_pk_bf16_f32 v50, v152, v153
    v_mfma_f32_16x16x32_bf16 v[136:139], a[176:179], a[136:139], v[136:139]
    v_cvt_pk_bf16_f32 v51, v154, v155
    ds_write_b64 v248, v[50:51] offset:2560
    v_mfma_f32_16x16x32_bf16 v[160:163], a[180:183], a[136:139], v[160:163]
    v_cvt_pk_bf16_f32 v52, v176, v177
    v_cvt_pk_bf16_f32 v53, v178, v179
    ds_write_b64 v248, v[52:53] offset:8192
    v_cvt_pk_bf16_f32 v54, v200, v201
    v_cvt_pk_bf16_f32 v55, v202, v203
    ds_write_b64 v248, v[54:55] offset:8704
    v_mfma_f32_16x16x32_bf16 v[184:187], a[184:187], a[136:139], v[184:187]
    s_add_u32 m0, s38, 78208
    v_cvt_pk_bf16_f32 v56, v132, v133
    v_cvt_pk_bf16_f32 v57, v134, v135
    v_mfma_f32_16x16x32_bf16 v[208:211], a[188:191], a[136:139], v[208:211]
    buffer_load_dwordx4 v3, s[12:15], s33 offen offset:2048 nt lds
    v_mfma_f32_16x16x32_bf16 v[140:143], a[176:179], a[140:143], v[140:143]
    ds_write_b64 v248, v[56:57] offset:3072
    v_cvt_pk_bf16_f32 v58, v156, v157
    v_mfma_f32_16x16x32_bf16 v[164:167], a[180:183], a[140:143], v[164:167]
    v_cvt_pk_bf16_f32 v59, v158, v159
    ds_write_b64 v248, v[58:59] offset:3584
    v_cvt_pk_bf16_f32 v60, v180, v181
    v_cvt_pk_bf16_f32 v61, v182, v183
    ds_write_b64 v248, v[60:61] offset:9216
    v_cvt_pk_bf16_f32 v62, v204, v205
    v_cvt_pk_bf16_f32 v63, v206, v207
    ds_write_b64 v248, v[62:63] offset:9728
    v_mfma_f32_16x16x32_bf16 v[188:191], a[184:187], a[140:143], v[188:191]
    v_mfma_f32_16x16x32_bf16 v[212:215], a[188:191], a[140:143], v[212:215]
    v_cvt_pk_bf16_f32 v64, v136, v137
    s_add_u32 m0, s38, 84480
    v_cvt_pk_bf16_f32 v65, v138, v139
    buffer_load_dwordx4 v4, s[12:15], s33 offen nt lds
    ds_write_b64 v248, v[64:65] offset:4096
    v_cvt_pk_bf16_f32 v66, v160, v161
    v_cvt_pk_bf16_f32 v67, v162, v163
    ds_write_b64 v248, v[66:67] offset:4608
    s_add_u32 m0, s38, 86656
    v_cvt_pk_bf16_f32 v68, v184, v185
    buffer_load_dwordx4 v4, s[12:15], s33 offen offset:2048 nt lds
    v_cvt_pk_bf16_f32 v69, v186, v187
    ds_write_b64 v248, v[68:69] offset:10240
    v_cvt_pk_bf16_f32 v70, v208, v209
    v_cvt_pk_bf16_f32 v71, v210, v211
    ds_write_b64 v248, v[70:71] offset:10752
    s_add_u32 m0, s38, 92928
    v_cvt_pk_bf16_f32 v72, v140, v141
    buffer_load_dwordx4 v5, s[12:15], s33 offen nt lds
    v_cvt_pk_bf16_f32 v73, v142, v143
    ds_write_b64 v248, v[72:73] offset:5120
    v_cvt_pk_bf16_f32 v74, v164, v165
    v_cvt_pk_bf16_f32 v75, v166, v167
    s_add_u32 m0, s38, 95104
    ds_write_b64 v248, v[74:75] offset:5632
    buffer_load_dwordx4 v5, s[12:15], s33 offen offset:2048 nt lds
    v_cvt_pk_bf16_f32 v76, v188, v189
    v_cvt_pk_bf16_f32 v77, v190, v191
    ds_write_b64 v248, v[76:77] offset:11264
    v_cvt_pk_bf16_f32 v78, v212, v213
    s_add_u32 s33, s33, 32768
    v_cvt_pk_bf16_f32 v79, v214, v215
    ds_write_b64 v248, v[78:79] offset:11776
    s_waitcnt vmcnt(16) lgkmcnt(0)
    s_barrier
    ds_read_b128 a[96:99], v6 offset:0
    ds_read_b128 a[100:103], v6 offset:8448
    ds_read_b128 a[0:3], v249 offset:0
    ds_read_b128 a[4:7], v249 offset:1024
    ds_read_b128 a[8:11], v249 offset:2048
    ds_read_b128 a[104:107], v6 offset:64
    ds_read_b128 a[108:111], v6 offset:8512
    ds_read_b128 a[12:15], v249 offset:6144
    ds_read_b128 a[16:19], v249 offset:7168
    ds_read_b128 a[20:23], v249 offset:8192
    ds_read_b128 a[112:115], v6 offset:128
    ds_read_b128 a[116:119], v6 offset:8576
    ds_read_b128 a[24:27], v249 offset:12288
    ds_read_b128 a[28:31], v249 offset:13312
    ds_read_b128 a[32:35], v249 offset:14336
    s_waitcnt lgkmcnt(12)
    v_mfma_f32_16x16x32_bf16 v[32:35], a[96:99], a[0:3], 0
    ds_read_b128 a[120:123], v6 offset:192
    ds_read_b128 a[124:127], v6 offset:8640
    s_waitcnt lgkmcnt(13)
    v_mfma_f32_16x16x32_bf16 v[36:39], a[96:99], a[4:7], 0
    ds_read_b128 a[36:39], v249 offset:18432
    ds_read_b128 a[40:43], v249 offset:19456
    s_waitcnt lgkmcnt(14)
    v_mfma_f32_16x16x32_bf16 v[40:43], a[96:99], a[8:11], 0
    ds_read_b128 a[44:47], v249 offset:20480
    ds_read_b128 a[128:131], v6 offset:256
    v_mfma_f32_16x16x32_bf16 v[44:47], a[100:103], a[0:3], 0
    ds_read_b128 a[132:135], v6 offset:8704
    ds_read_b128 a[48:51], v249 offset:24576
    v_mfma_f32_16x16x32_bf16 v[48:51], a[100:103], a[4:7], 0
    ds_read_b128 a[52:55], v249 offset:25600
    ds_read_b128 a[56:59], v249 offset:26624
    v_mfma_f32_16x16x32_bf16 v[52:55], a[100:103], a[8:11], 0
    ds_read_b128 a[136:139], v6 offset:320
    ds_read_b128 a[140:143], v6 offset:8768
    s_waitcnt lgkmcnt(15)
    v_mfma_f32_16x16x32_bf16 v[32:35], a[104:107], a[12:15], v[32:35]
    ds_read_b128 a[60:63], v249 offset:30720
    ds_read_b128 a[64:67], v249 offset:31744
    v_mfma_f32_16x16x32_bf16 v[36:39], a[104:107], a[16:19], v[36:39]
    ds_read_b128 a[68:71], v249 offset:32768
    v_mfma_f32_16x16x32_bf16 v[40:43], a[104:107], a[20:23], v[40:43]
    ds_read_b128 a[144:147], v6 offset:384
    v_mfma_f32_16x16x32_bf16 v[44:47], a[108:111], a[12:15], v[44:47]
    ds_read_b128 a[148:151], v6 offset:8832
    ds_read_b128 a[72:75], v249 offset:36864
    v_mfma_f32_16x16x32_bf16 v[48:51], a[108:111], a[16:19], v[48:51]
    ds_read_b128 a[76:79], v249 offset:37888
    v_mfma_f32_16x16x32_bf16 v[52:55], a[108:111], a[20:23], v[52:55]
    ds_read_b128 a[80:83], v249 offset:38912
    s_waitcnt lgkmcnt(15)
    v_mfma_f32_16x16x32_bf16 v[32:35], a[112:115], a[24:27], v[32:35]
    ds_read_b128 a[152:155], v6 offset:448
    v_mfma_f32_16x16x32_bf16 v[36:39], a[112:115], a[28:31], v[36:39]
    ds_read_b128 a[156:159], v6 offset:8896
    v_mfma_f32_16x16x32_bf16 v[40:43], a[112:115], a[32:35], v[40:43]
    ds_read_b128 a[84:87], v249 offset:43008
    v_mfma_f32_16x16x32_bf16 v[44:47], a[116:119], a[24:27], v[44:47]
    ds_read_b128 a[88:91], v249 offset:44032
    v_mfma_f32_16x16x32_bf16 v[48:51], a[116:119], a[28:31], v[48:51]
    ds_read_b128 a[92:95], v249 offset:45056
    v_mfma_f32_16x16x32_bf16 v[52:55], a[116:119], a[32:35], v[52:55]
    v_mfma_f32_16x16x32_bf16 v[32:35], a[120:123], a[36:39], v[32:35]
    v_mfma_f32_16x16x32_bf16 v[36:39], a[120:123], a[40:43], v[36:39]
    v_mfma_f32_16x16x32_bf16 v[40:43], a[120:123], a[44:47], v[40:43]
    v_mfma_f32_16x16x32_bf16 v[44:47], a[124:127], a[36:39], v[44:47]
    v_mfma_f32_16x16x32_bf16 v[48:51], a[124:127], a[40:43], v[48:51]
    v_mfma_f32_16x16x32_bf16 v[52:55], a[124:127], a[44:47], v[52:55]
    s_waitcnt lgkmcnt(15)
    v_mfma_f32_16x16x32_bf16 v[32:35], a[128:131], a[48:51], v[32:35]
    v_mfma_f32_16x16x32_bf16 v[36:39], a[128:131], a[52:55], v[36:39]
    v_mfma_f32_16x16x32_bf16 v[40:43], a[128:131], a[56:59], v[40:43]
    v_mfma_f32_16x16x32_bf16 v[44:47], a[132:135], a[48:51], v[44:47]
    v_mfma_f32_16x16x32_bf16 v[48:51], a[132:135], a[52:55], v[48:51]
    v_mfma_f32_16x16x32_bf16 v[52:55], a[132:135], a[56:59], v[52:55]
    s_waitcnt vmcnt(8) lgkmcnt(0)
    s_barrier
    v_mfma_f32_16x16x32_bf16 v[32:35], a[136:139], a[60:63], v[32:35]
    s_add_u32 m0, s38, 0
    ds_read_b128 a[96:99], v6 offset:33792
    v_mfma_f32_16x16x32_bf16 v[36:39], a[136:139], a[64:67], v[36:39]
    buffer_load_dwordx4 v2, s[8:11], s32 offen nt lds
    v_mfma_f32_16x16x32_bf16 v[40:43], a[136:139], a[68:71], v[40:43]
    ds_read_b128 a[100:103], v6 offset:42240
    ds_read_b128 a[104:107], v6 offset:33856
    v_mfma_f32_16x16x32_bf16 v[44:47], a[140:143], a[60:63], v[44:47]
    s_add_u32 m0, s38, 2176
    ds_read_b128 a[108:111], v6 offset:42304
    v_mfma_f32_16x16x32_bf16 v[48:51], a[140:143], a[64:67], v[48:51]
    buffer_load_dwordx4 v2, s[8:11], s32 offen offset:2048 nt lds
    v_mfma_f32_16x16x32_bf16 v[52:55], a[140:143], a[68:71], v[52:55]
    ds_read_b128 a[112:115], v6 offset:33920
    ds_read_b128 a[116:119], v6 offset:42368
    v_mfma_f32_16x16x32_bf16 v[32:35], a[144:147], a[72:75], v[32:35]
    ds_read_b128 a[120:123], v6 offset:33984
    ds_read_b128 a[124:127], v6 offset:42432
    v_mfma_f32_16x16x32_bf16 v[36:39], a[144:147], a[76:79], v[36:39]
    s_add_u32 m0, s38, 8448
    ds_read_b128 a[128:131], v6 offset:34048
    v_mfma_f32_16x16x32_bf16 v[40:43], a[144:147], a[80:83], v[40:43]
    buffer_load_dwordx4 v3, s[8:11], s32 offen nt lds
    v_mfma_f32_16x16x32_bf16 v[44:47], a[148:151], a[72:75], v[44:47]
    ds_read_b128 a[132:135], v6 offset:42496
    v_mfma_f32_16x16x32_bf16 v[48:51], a[148:151], a[76:79], v[48:51]
    s_add_u32 m0, s38, 10624
    v_mfma_f32_16x16x32_bf16 v[52:55], a[148:151], a[80:83], v[52:55]
    buffer_load_dwordx4 v3, s[8:11], s32 offen offset:2048 nt lds
    v_mfma_f32_16x16x32_bf16 v[32:35], a[152:155], a[84:87], v[32:35]
    ds_read_b128 a[136:139], v6 offset:34112
    ds_read_b128 a[140:143], v6 offset:42560
    v_mfma_f32_16x16x32_bf16 v[36:39], a[152:155], a[88:91], v[36:39]
    ds_read_b128 a[144:147], v6 offset:34176
    ds_read_b128 a[148:151], v6 offset:42624
    v_mfma_f32_16x16x32_bf16 v[40:43], a[152:155], a[92:95], v[40:43]
    s_add_u32 m0, s38, 16896
    v_mfma_f32_16x16x32_bf16 v[44:47], a[156:159], a[84:87], v[44:47]
    buffer_load_dwordx4 v4, s[8:11], s32 offen nt lds
    v_mfma_f32_16x16x32_bf16 v[48:51], a[156:159], a[88:91], v[48:51]
    v_mfma_f32_16x16x32_bf16 v[52:55], a[156:159], a[92:95], v[52:55]
    ds_read_b128 a[152:155], v6 offset:34240
    s_add_u32 m0, s38, 19072
    ds_read_b128 a[156:159], v6 offset:42688
    buffer_load_dwordx4 v4, s[8:11], s32 offen offset:2048 nt lds
    v_max3_f32 v21, v32, v33, v34
    v_max3_f32 v21, v21, v35, v44
    v_max3_f32 v21, v21, v45, v46
    v_max_f32 v21, v21, v47
    v_max3_f32 v22, v36, v37, v38
    v_max3_f32 v22, v22, v39, v48
    v_max3_f32 v22, v22, v49, v50
    v_max_f32 v22, v22, v51
    v_max3_f32 v23, v40, v41, v42
    s_add_u32 m0, s38, 25344
    v_max3_f32 v23, v23, v43, v52
    buffer_load_dwordx4 v5, s[8:11], s32 offen nt lds
    v_max3_f32 v23, v23, v53, v54
    v_max_f32 v23, v23, v55
    ds_write_b32 v28, v21 offset:12288
    ds_write_b32 v28, v22 offset:12544
    ds_write_b32 v28, v23 offset:12800
    v_mul_f32 v56, s36, v32
    v_mul_f32 v57, s36, v33
    v_mul_f32 v58, s36, v34
    v_mul_f32 v59, s36, v35
    s_add_u32 m0, s38, 27520
    v_mul_f32 v60, s36, v36
    buffer_load_dwordx4 v5, s[8:11], s32 offen offset:2048 nt lds
    v_mul_f32 v61, s36, v37
    v_mul_f32 v62, s36, v38
    v_mul_f32 v63, s36, v39
    v_mul_f32 v64, s36, v40
    v_mul_f32 v65, s36, v41
    v_mul_f32 v66, s36, v42
    v_mul_f32 v67, s36, v43
    v_mul_f32 v68, s36, v44
    s_add_u32 s32, s32, 32768
    v_mul_f32 v69, s36, v45
    v_mul_f32 v70, s36, v46
    v_mul_f32 v71, s36, v47
    v_mul_f32 v72, s36, v48
    v_mul_f32 v73, s36, v49
    v_mul_f32 v74, s36, v50
    v_mul_f32 v75, s36, v51
    v_mul_f32 v76, s36, v52
    v_mul_f32 v77, s36, v53
    v_mul_f32 v78, s36, v54
    v_mul_f32 v79, s36, v55
    s_waitcnt vmcnt(8) lgkmcnt(0)
    s_barrier
    ds_read_b128 v[80:83], v29 offset:12288
    ds_read_b128 v[92:95], v30 offset:12288
    ds_read_b128 v[84:87], v29 offset:12544
    ds_read_b128 v[96:99], v30 offset:12544
    ds_read_b128 v[88:91], v29 offset:12800
    ds_read_b128 v[100:103], v30 offset:12800
    v_mfma_f32_16x16x32_bf16 v[32:35], a[96:99], a[0:3], 0
    ds_read_b64_tr_b16 a[160:161], v7 offset:0
    ds_read_b64_tr_b16 a[162:163], v7 offset:8448
    ds_read_b64_tr_b16 a[164:165], v7 offset:32
    v_mfma_f32_16x16x32_bf16 v[36:39], a[96:99], a[4:7], 0
    s_add_u32 m0, s38, 101376
    ds_read_b64_tr_b16 a[166:167], v7 offset:8480
    ds_read_b64_tr_b16 a[168:169], v7 offset:64
    v_mfma_f32_16x16x32_bf16 v[40:43], a[96:99], a[8:11], 0
    buffer_load_dwordx4 v2, s[12:15], s33 offen nt lds
    ds_read_b64_tr_b16 a[170:171], v7 offset:8512
    ds_read_b64_tr_b16 a[172:173], v7 offset:96
    v_mfma_f32_16x16x32_bf16 v[44:47], a[100:103], a[0:3], 0
    v_mfma_f32_16x16x32_bf16 v[48:51], a[100:103], a[4:7], 0
    ds_read_b64_tr_b16 a[174:175], v7 offset:8544
    v_mfma_f32_16x16x32_bf16 v[52:55], a[100:103], a[8:11], 0
    ds_read_b64_tr_b16 a[176:177], v7 offset:128
    v_mfma_f32_16x16x32_bf16 v[32:35], a[104:107], a[12:15], v[32:35]
    s_add_u32 m0, s38, 103552
    s_waitcnt lgkmcnt(14)
    v_max3_f32 v16, v80, v81, v82
    s_waitcnt lgkmcnt(13)
    v_max3_f32 v16, v16, v83, v92
    v_max3_f32 v16, v16, v93, v94
    v_mfma_f32_16x16x32_bf16 v[36:39], a[104:107], a[16:19], v[36:39]
    buffer_load_dwordx4 v2, s[12:15], s33 offen offset:2048 nt lds
    v_max_f32 v16, v16, v95
    v_mul_f32 v16, s36, v16
    v_mfma_f32_16x16x32_bf16 v[40:43], a[104:107], a[20:23], v[40:43]
    v_ceil_f32 v16, v16
    s_waitcnt lgkmcnt(12)
    v_max3_f32 v17, v84, v85, v86
    s_waitcnt lgkmcnt(11)
    v_max3_f32 v17, v17, v87, v96
    v_mfma_f32_16x16x32_bf16 v[44:47], a[108:111], a[12:15], v[44:47]
    v_max3_f32 v17, v17, v97, v98
    v_max_f32 v17, v17, v99
    v_mul_f32 v17, s36, v17
    v_mfma_f32_16x16x32_bf16 v[48:51], a[108:111], a[16:19], v[48:51]
    v_ceil_f32 v17, v17
    s_waitcnt lgkmcnt(10)
    v_max3_f32 v18, v88, v89, v90
    s_waitcnt lgkmcnt(9)
    v_max3_f32 v18, v18, v91, v100
    v_mfma_f32_16x16x32_bf16 v[52:55], a[108:111], a[20:23], v[52:55]
    v_max3_f32 v18, v18, v101, v102
    v_max_f32 v18, v18, v103
    v_mul_f32 v18, s36, v18
    v_mfma_f32_16x16x32_bf16 v[32:35], a[112:115], a[24:27], v[32:35]
    s_add_u32 m0, s38, 109824
    ds_read_b64_tr_b16 a[178:179], v7 offset:8576
    v_ceil_f32 v18, v18
    v_sub_f32 v56, v56, v16
    v_mfma_f32_16x16x32_bf16 v[36:39], a[112:115], a[28:31], v[36:39]
    buffer_load_dwordx4 v3, s[12:15], s33 offen nt lds
    v_sub_f32 v57, v57, v16
    v_sub_f32 v58, v58, v16
    v_mfma_f32_16x16x32_bf16 v[40:43], a[112:115], a[32:35], v[40:43]
    ds_read_b64_tr_b16 a[180:181], v7 offset:160
    v_sub_f32 v59, v59, v16
    v_sub_f32 v68, v68, v16
    v_mfma_f32_16x16x32_bf16 v[44:47], a[116:119], a[24:27], v[44:47]
    v_sub_f32 v69, v69, v16
    v_sub_f32 v70, v70, v16
    ds_read_b64_tr_b16 a[182:183], v7 offset:8608
    v_mfma_f32_16x16x32_bf16 v[48:51], a[116:119], a[28:31], v[48:51]
    v_sub_f32 v71, v71, v16
    v_sub_f32 v60, v60, v17
    v_sub_f32 v61, v61, v17
    v_mfma_f32_16x16x32_bf16 v[52:55], a[116:119], a[32:35], v[52:55]
    v_sub_f32 v62, v62, v17
    ds_read_b64_tr_b16 a[184:185], v7 offset:192
    v_sub_f32 v63, v63, v17
    v_mfma_f32_16x16x32_bf16 v[32:35], a[120:123], a[36:39], v[32:35]
    s_add_u32 m0, s38, 112000
    v_sub_f32 v72, v72, v17
    v_sub_f32 v73, v73, v17
    v_sub_f32 v74, v74, v17
    v_mfma_f32_16x16x32_bf16 v[36:39], a[120:123], a[40:43], v[36:39]
    buffer_load_dwordx4 v3, s[12:15], s33 offen offset:2048 nt lds
    ds_read_b64_tr_b16 a[186:187], v7 offset:8640
    v_sub_f32 v75, v75, v17
    v_mfma_f32_16x16x32_bf16 v[40:43], a[120:123], a[44:47], v[40:43]
    v_sub_f32 v64, v64, v18
    v_sub_f32 v65, v65, v18
    v_sub_f32 v66, v66, v18
    v_mfma_f32_16x16x32_bf16 v[44:47], a[124:127], a[36:39], v[44:47]
    ds_read_b64_tr_b16 a[188:189], v7 offset:224
    v_sub_f32 v67, v67, v18
    v_sub_f32 v76, v76, v18
    v_sub_f32 v77, v77, v18
    v_mfma_f32_16x16x32_bf16 v[48:51], a[124:127], a[40:43], v[48:51]
    v_sub_f32 v78, v78, v18
    ds_read_b64_tr_b16 a[190:191], v7 offset:8672
    v_sub_f32 v79, v79, v18
    ds_read_b64_tr_b16 a[192:193], v8 offset:0
    v_mfma_f32_16x16x32_bf16 v[52:55], a[124:127], a[44:47], v[52:55]
    v_exp_f32 v216, v56
    ds_read_b64_tr_b16 a[194:195], v8 offset:8448
    v_mfma_f32_16x16x32_bf16 v[32:35], a[128:131], a[48:51], v[32:35]
    s_add_u32 m0, s38, 118272
    v_exp_f32 v217, v57
    ds_read_b64_tr_b16 a[196:197], v8 offset:32
    v_mfma_f32_16x16x32_bf16 v[36:39], a[128:131], a[52:55], v[36:39]
    buffer_load_dwordx4 v4, s[12:15], s33 offen nt lds
    v_exp_f32 v218, v58
    v_mfma_f32_16x16x32_bf16 v[40:43], a[128:131], a[56:59], v[40:43]
    v_exp_f32 v219, v59
    v_exp_f32 v228, v68
    v_mfma_f32_16x16x32_bf16 v[44:47], a[132:135], a[48:51], v[44:47]
    v_exp_f32 v229, v69
    v_exp_f32 v230, v70
    v_mfma_f32_16x16x32_bf16 v[48:51], a[132:135], a[52:55], v[48:51]
    ds_read_b64_tr_b16 a[198:199], v8 offset:8480
    v_exp_f32 v231, v71
    ds_read_b64_tr_b16 a[200:201], v8 offset:64
    v_mfma_f32_16x16x32_bf16 v[52:55], a[132:135], a[56:59], v[52:55]
    s_add_u32 m0, s38, 120448
    v_exp_f32 v220, v60
    v_cvt_pk_bf16_f32 v80, v216, v217
    v_mfma_f32_16x16x32_bf16 v[32:35], a[136:139], a[60:63], v[32:35]
    buffer_load_dwordx4 v4, s[12:15], s33 offen offset:2048 nt lds
    v_cvt_pk_bf16_f32 v81, v218, v219
    v_cvt_pk_bf16_f32 v82, v228, v229
    v_mfma_f32_16x16x32_bf16 v[36:39], a[136:139], a[64:67], v[36:39]
    v_cvt_pk_bf16_f32 v83, v230, v231
    ds_read_b64_tr_b16 a[202:203], v8 offset:8512
    ds_read_b64_tr_b16 a[204:205], v8 offset:96
    ds_read_b64_tr_b16 a[206:207], v8 offset:8544
    v_mfma_f32_16x16x32_bf16 v[40:43], a[136:139], a[68:71], v[40:43]
    ds_write_b128 v9, v[80:83] offset:0
    v_mfma_f32_16x16x32_bf16 v[44:47], a[140:143], a[60:63], v[44:47]
    v_exp_f32 v221, v61
    v_exp_f32 v222, v62
    v_mfma_f32_16x16x32_bf16 v[48:51], a[140:143], a[64:67], v[48:51]
    v_exp_f32 v223, v63
    v_exp_f32 v232, v72
    v_mfma_f32_16x16x32_bf16 v[52:55], a[140:143], a[68:71], v[52:55]
    s_add_u32 m0, s38, 126720
    ds_read_b64_tr_b16 a[208:209], v8 offset:128
    v_exp_f32 v233, v73
    v_mfma_f32_16x16x32_bf16 v[32:35], a[144:147], a[72:75], v[32:35]
    buffer_load_dwordx4 v5, s[12:15], s33 offen nt lds
    v_exp_f32 v234, v74
    v_mfma_f32_16x16x32_bf16 v[36:39], a[144:147], a[76:79], v[36:39]
    ds_read_b64_tr_b16 a[210:211], v8 offset:8576
    v_exp_f32 v235, v75
    ds_read_b64_tr_b16 a[212:213], v8 offset:160
    v_mfma_f32_16x16x32_bf16 v[40:43], a[144:147], a[80:83], v[40:43]
    v_exp_f32 v224, v64
    v_cvt_pk_bf16_f32 v84, v220, v221
    v_cvt_pk_bf16_f32 v85, v222, v223
    v_mfma_f32_16x16x32_bf16 v[44:47], a[148:151], a[72:75], v[44:47]
    v_cvt_pk_bf16_f32 v86, v232, v233
    ds_read_b64_tr_b16 a[214:215], v8 offset:8608
    v_cvt_pk_bf16_f32 v87, v234, v235
    ds_read_b64_tr_b16 a[216:217], v8 offset:192
    v_mfma_f32_16x16x32_bf16 v[48:51], a[148:151], a[76:79], v[48:51]
    ds_write_b128 v9, v[84:87] offset:1024
    v_mfma_f32_16x16x32_bf16 v[52:55], a[148:151], a[80:83], v[52:55]
    ds_read_b64_tr_b16 a[218:219], v8 offset:8640
    ds_read_b64_tr_b16 a[220:221], v8 offset:224
    ds_read_b64_tr_b16 a[222:223], v8 offset:8672
    s_add_u32 m0, s38, 128896
    v_mfma_f32_16x16x32_bf16 v[32:35], a[152:155], a[84:87], v[32:35]
    v_exp_f32 v225, v65
    buffer_load_dwordx4 v5, s[12:15], s33 offen offset:2048 nt lds
    v_mfma_f32_16x16x32_bf16 v[36:39], a[152:155], a[88:91], v[36:39]
    v_exp_f32 v226, v66
    v_exp_f32 v227, v67
    v_mfma_f32_16x16x32_bf16 v[40:43], a[152:155], a[92:95], v[40:43]
    v_exp_f32 v236, v76
    v_exp_f32 v237, v77
    v_exp_f32 v238, v78
    v_exp_f32 v239, v79
    v_cvt_pk_bf16_f32 v88, v224, v225
    v_cvt_pk_bf16_f32 v89, v226, v227
    v_cvt_pk_bf16_f32 v90, v236, v237
    v_cvt_pk_bf16_f32 v91, v238, v239
    ds_write_b128 v9, v[88:91] offset:2048
    v_mfma_f32_16x16x32_bf16 v[44:47], a[156:159], a[84:87], v[44:47]
    v_mfma_f32_16x16x32_bf16 v[48:51], a[156:159], a[88:91], v[48:51]
    s_add_u32 s33, s33, 32768
    v_mfma_f32_16x16x32_bf16 v[52:55], a[156:159], a[92:95], v[52:55]
    s_waitcnt vmcnt(8) lgkmcnt(0)
    s_barrier
    v_mfma_f32_16x16x32_bf16 v[120:123], a[160:163], v[80:83], 0
    ds_read_b128 v[92:95], v10 offset:0
    ds_read_b128 v[96:99], v10 offset:1024
    v_mfma_f32_16x16x32_bf16 v[124:127], a[160:163], v[84:87], 0
    s_add_u32 m0, s38, 33792
    ds_read_b128 v[100:103], v10 offset:2048
    v_mfma_f32_16x16x32_bf16 v[128:131], a[160:163], v[88:91], 0
    buffer_load_dwordx4 v2, s[8:11], s32 offen nt lds
    v_mfma_f32_16x16x32_bf16 v[132:135], a[164:167], v[80:83], 0
    v_fma_f32 v56, v32, s36, -v16
    v_fma_f32 v57, v33, s36, -v16
    v_mfma_f32_16x16x32_bf16 v[136:139], a[164:167], v[84:87], 0
    ds_read_b128 a[96:99], v6 offset:0
    v_fma_f32 v58, v34, s36, -v16
    v_mfma_f32_16x16x32_bf16 v[140:143], a[164:167], v[88:91], 0
    v_fma_f32 v59, v35, s36, -v16
    v_fma_f32 v68, v44, s36, -v16
    v_mfma_f32_16x16x32_bf16 v[144:147], a[168:171], v[80:83], 0
    ds_read_b128 a[100:103], v6 offset:8448
    v_fma_f32 v69, v45, s36, -v16
    v_mfma_f32_16x16x32_bf16 v[148:151], a[168:171], v[84:87], 0
    s_add_u32 m0, s38, 35968
    v_fma_f32 v70, v46, s36, -v16
    v_mfma_f32_16x16x32_bf16 v[152:155], a[168:171], v[88:91], 0
    buffer_load_dwordx4 v2, s[8:11], s32 offen offset:2048 nt lds
    v_mfma_f32_16x16x32_bf16 v[156:159], a[172:175], v[80:83], 0
    v_fma_f32 v71, v47, s36, -v16
    v_fma_f32 v60, v36, s36, -v17
    v_mfma_f32_16x16x32_bf16 v[160:163], a[172:175], v[84:87], 0
    ds_read_b128 a[104:107], v6 offset:64
    v_max3_f32 v19, v56, v57, v58
    v_mfma_f32_16x16x32_bf16 v[164:167], a[172:175], v[88:91], 0
    v_max3_f32 v19, v19, v59, v68
    v_max3_f32 v19, v19, v69, v70
    v_mfma_f32_16x16x32_bf16 v[168:171], a[176:179], v[80:83], 0
    ds_read_b128 a[108:111], v6 offset:8512
    v_max3_f32 v19, v19, v71, v60
    v_mfma_f32_16x16x32_bf16 v[172:175], a[176:179], v[84:87], 0
    v_fma_f32 v61, v37, s36, -v17
    v_fma_f32 v62, v38, s36, -v17
    v_mfma_f32_16x16x32_bf16 v[176:179], a[176:179], v[88:91], 0
    s_add_u32 m0, s38, 42240
    v_fma_f32 v63, v39, s36, -v17
    v_mfma_f32_16x16x32_bf16 v[180:183], a[180:183], v[80:83], 0
    buffer_load_dwordx4 v3, s[8:11], s32 offen nt lds
    v_mfma_f32_16x16x32_bf16 v[184:187], a[180:183], v[84:87], 0
    ds_read_b128 a[112:115], v6 offset:128
    v_fma_f32 v72, v48, s36, -v17
    v_mfma_f32_16x16x32_bf16 v[188:191], a[180:183], v[88:91], 0
    v_fma_f32 v73, v49, s36, -v17
    v_fma_f32 v74, v50, s36, -v17
    v_mfma_f32_16x16x32_bf16 v[192:195], a[184:187], v[80:83], 0
    v_fma_f32 v75, v51, s36, -v17
    ds_read_b128 a[116:119], v6 offset:8576
    v_mfma_f32_16x16x32_bf16 v[196:199], a[184:187], v[84:87], 0
    v_fma_f32 v64, v40, s36, -v18
    v_max3_f32 v19, v19, v61, v62
    v_mfma_f32_16x16x32_bf16 v[200:203], a[184:187], v[88:91], 0
    s_add_u32 m0, s38, 44416
    v_max3_f32 v19, v19, v63, v72
    v_mfma_f32_16x16x32_bf16 v[204:207], a[188:191], v[80:83], 0
    buffer_load_dwordx4 v3, s[8:11], s32 offen offset:2048 nt lds
    v_mfma_f32_16x16x32_bf16 v[208:211], a[188:191], v[84:87], 0
    ds_read_b128 a[120:123], v6 offset:192
    v_max3_f32 v19, v19, v73, v74
    v_mfma_f32_16x16x32_bf16 v[212:215], a[188:191], v[88:91], 0
    v_max3_f32 v19, v19, v75, v64
    v_fma_f32 v65, v41, s36, -v18
    v_mfma_f32_16x16x32_bf16 v[104:107], v[116:119], v[80:83], v[104:107]
    v_fma_f32 v66, v42, s36, -v18
    ds_read_b128 a[124:127], v6 offset:8640
    v_mfma_f32_16x16x32_bf16 v[108:111], v[116:119], v[84:87], v[108:111]
    v_fma_f32 v67, v43, s36, -v18
    v_fma_f32 v76, v52, s36, -v18
    v_mfma_f32_16x16x32_bf16 v[112:115], v[116:119], v[88:91], v[112:115]
    v_fma_f32 v77, v53, s36, -v18
    ds_read_b128 a[128:131], v6 offset:256
    s_waitcnt lgkmcnt(11)
    v_mfma_f32_16x16x32_bf16 v[120:123], a[192:195], v[92:95], v[120:123]
    s_add_u32 m0, s38, 50688
    v_fma_f32 v78, v54, s36, -v18
    s_waitcnt lgkmcnt(10)
    v_mfma_f32_16x16x32_bf16 v[124:127], a[192:195], v[96:99], v[124:127]
    buffer_load_dwordx4 v4, s[8:11], s32 offen nt lds
    s_waitcnt lgkmcnt(9)
    v_mfma_f32_16x16x32_bf16 v[128:131], a[192:195], v[100:103], v[128:131]
    v_fma_f32 v79, v55, s36, -v18
    v_max3_f32 v19, v19, v65, v66
    v_mfma_f32_16x16x32_bf16 v[132:135], a[196:199], v[92:95], v[132:135]
    v_max3_f32 v19, v19, v67, v76
    ds_read_b128 a[132:135], v6 offset:8704
    v_mfma_f32_16x16x32_bf16 v[136:139], a[196:199], v[96:99], v[136:139]
    v_max3_f32 v19, v19, v77, v78
    v_max_f32 v19, v19, v79
    v_mfma_f32_16x16x32_bf16 v[140:143], a[196:199], v[100:103], v[140:143]
    v_cmp_lt_f32 vcc, s37, v19
    ds_read_b128 a[136:139], v6 offset:320
    v_mfma_f32_16x16x32_bf16 v[144:147], a[200:203], v[92:95], v[144:147]
    s_add_u32 m0, s38, 52864
    ds_read_b128 a[140:143], v6 offset:8768
    v_mfma_f32_16x16x32_bf16 v[148:151], a[200:203], v[96:99], v[148:151]
    buffer_load_dwordx4 v4, s[8:11], s32 offen offset:2048 nt lds
    v_mfma_f32_16x16x32_bf16 v[152:155], a[200:203], v[100:103], v[152:155]
    v_exp_f32 v216, v56
    v_mfma_f32_16x16x32_bf16 v[156:159], a[204:207], v[92:95], v[156:159]
    v_exp_f32 v217, v57
    v_mfma_f32_16x16x32_bf16 v[160:163], a[204:207], v[96:99], v[160:163]
    v_exp_f32 v218, v58
    v_mfma_f32_16x16x32_bf16 v[164:167], a[204:207], v[100:103], v[164:167]
    v_exp_f32 v219, v59
    v_mfma_f32_16x16x32_bf16 v[168:171], a[208:211], v[92:95], v[168:171]
    ds_read_b128 a[144:147], v6 offset:384
    ds_read_b128 a[148:151], v6 offset:8832
    v_mfma_f32_16x16x32_bf16 v[172:175], a[208:211], v[96:99], v[172:175]
    s_add_u32 m0, s38, 59136
    ds_read_b128 a[152:155], v6 offset:448
    v_mfma_f32_16x16x32_bf16 v[176:179], a[208:211], v[100:103], v[176:179]
    v_exp_f32 v228, v68
    buffer_load_dwordx4 v5, s[8:11], s32 offen nt lds
    v_mfma_f32_16x16x32_bf16 v[180:183], a[212:215], v[92:95], v[180:183]
    v_exp_f32 v229, v69
    v_mfma_f32_16x16x32_bf16 v[184:187], a[212:215], v[96:99], v[184:187]
    v_exp_f32 v230, v70
    v_mfma_f32_16x16x32_bf16 v[188:191], a[212:215], v[100:103], v[188:191]
    v_exp_f32 v231, v71
    v_mfma_f32_16x16x32_bf16 v[192:195], a[216:219], v[92:95], v[192:195]
    v_exp_f32 v220, v60
    v_mfma_f32_16x16x32_bf16 v[196:199], a[216:219], v[96:99], v[196:199]
    ds_read_b128 a[156:159], v6 offset:8896
    s_add_u32 m0, s38, 61312
    v_mfma_f32_16x16x32_bf16 v[200:203], a[216:219], v[100:103], v[200:203]
    buffer_load_dwordx4 v5, s[8:11], s32 offen offset:2048 nt lds
    v_mfma_f32_16x16x32_bf16 v[204:207], a[220:223], v[92:95], v[204:207]
    v_exp_f32 v221, v61
    v_mfma_f32_16x16x32_bf16 v[208:211], a[220:223], v[96:99], v[208:211]
    v_exp_f32 v222, v62
    v_mfma_f32_16x16x32_bf16 v[212:215], a[220:223], v[100:103], v[212:215]
    v_exp_f32 v223, v63
    v_mfma_f32_16x16x32_bf16 v[104:107], v[116:119], v[92:95], v[104:107]
    v_exp_f32 v232, v72
    v_mfma_f32_16x16x32_bf16 v[108:111], v[116:119], v[96:99], v[108:111]
    v_exp_f32 v233, v73
    s_cbranch_vccnz L_sf0
L_sb0:
    s_add_u32 s32, s32, 32768
    v_mfma_f32_16x16x32_bf16 v[112:115], v[116:119], v[100:103], v[112:115]
    s_mov_b32 s39, 0
.p2align 3
L_loop:
    s_waitcnt vmcnt(8) lgkmcnt(0)
    s_barrier
    ds_read_b32 v20, v14
    v_mfma_f32_16x16x32_bf16 v[32:35], a[96:99], a[0:3], 0
    ds_read_b64_tr_b16 a[160:161], v7 offset:33792
    ds_read_b64_tr_b16 a[162:163], v7 offset:42240
    v_mfma_f32_16x16x32_bf16 v[36:39], a[96:99], a[4:7], 0
    s_add_u32 m0, s38, 67584
    ds_read_b64_tr_b16 a[164:165], v7 offset:33824
    v_mfma_f32_16x16x32_bf16 v[40:43], a[96:99], a[8:11], 0
    buffer_load_dwordx4 v2, s[12:15], s33 offen nt lds
    v_mfma_f32_16x16x32_bf16 v[44:47], a[100:103], a[0:3], 0
    ds_read_b64_tr_b16 a[166:167], v7 offset:42272
    ds_read_b64_tr_b16 a[168:169], v7 offset:33856
    v_mfma_f32_16x16x32_bf16 v[48:51], a[100:103], a[4:7], 0
    ds_read_b64_tr_b16 a[170:171], v7 offset:42304
    ds_read_b64_tr_b16 a[172:173], v7 offset:33888
    v_mfma_f32_16x16x32_bf16 v[52:55], a[100:103], a[8:11], 0
    ds_read_b64_tr_b16 a[174:175], v7 offset:42336
    ds_read_b64_tr_b16 a[176:177], v7 offset:33920
    v_mfma_f32_16x16x32_bf16 v[32:35], a[104:107], a[12:15], v[32:35]
    s_add_u32 m0, s38, 69760
    ds_read_b64_tr_b16 a[178:179], v7 offset:42368
    v_mfma_f32_16x16x32_bf16 v[36:39], a[104:107], a[16:19], v[36:39]
    s_waitcnt lgkmcnt(10)
    v_readfirstlane_b32 s45, v20
    buffer_load_dwordx4 v2, s[12:15], s33 offen offset:2048 nt lds
    v_mfma_f32_16x16x32_bf16 v[40:43], a[104:107], a[20:23], v[40:43]
    ds_read_b64_tr_b16 a[180:181], v7 offset:33952
    v_mfma_f32_16x16x32_bf16 v[44:47], a[108:111], a[12:15], v[44:47]
    s_cmp_eq_u32 s45, 0
    s_cbranch_scc0 L_call0
L_back0:
    v_mfma_f32_16x16x32_bf16 v[48:51], a[108:111], a[16:19], v[48:51]
    v_cvt_pk_bf16_f32 v80, v216, v217
    v_cvt_pk_bf16_f32 v81, v218, v219
    v_mfma_f32_16x16x32_bf16 v[52:55], a[108:111], a[20:23], v[52:55]
    v_cvt_pk_bf16_f32 v82, v228, v229
    v_cvt_pk_bf16_f32 v83, v230, v231
    v_mfma_f32_16x16x32_bf16 v[32:35], a[112:115], a[24:27], v[32:35]
    s_add_u32 m0, s38, 76032
    ds_read_b64_tr_b16 a[182:183], v7 offset:42400
    v_mfma_f32_16x16x32_bf16 v[36:39], a[112:115], a[28:31], v[36:39]
    buffer_load_dwordx4 v3, s[12:15], s33 offen nt lds
    v_mfma_f32_16x16x32_bf16 v[40:43], a[112:115], a[32:35], v[40:43]
    ds_write_b128 v9, v[80:83] offset:0
    v_mfma_f32_16x16x32_bf16 v[44:47], a[116:119], a[24:27], v[44:47]
    ds_read_b64_tr_b16 a[184:185], v7 offset:33984
    ds_read_b64_tr_b16 a[186:187], v7 offset:42432
    v_mfma_f32_16x16x32_bf16 v[48:51], a[116:119], a[28:31], v[48:51]
    v_exp_f32 v234, v74
    v_mfma_f32_16x16x32_bf16 v[52:55], a[116:119], a[32:35], v[52:55]
    v_exp_f32 v235, v75
    v_mfma_f32_16x16x32_bf16 v[32:35], a[120:123], a[36:39], v[32:35]
    s_add_u32 m0, s38, 78208
    ds_read_b64_tr_b16 a[188:189], v7 offset:34016
    v_mfma_f32_16x16x32_bf16 v[36:39], a[120:123], a[40:43], v[36:39]
    buffer_load_dwordx4 v3, s[12:15], s33 offen offset:2048 nt lds
    v_mfma_f32_16x16x32_bf16 v[40:43], a[120:123], a[44:47], v[40:43]
    v_exp_f32 v224, v64
    v_mfma_f32_16x16x32_bf16 v[44:47], a[124:127], a[36:39], v[44:47]
    ds_read_b64_tr_b16 a[190:191], v7 offset:42464
    v_cvt_pk_bf16_f32 v84, v220, v221
    v_mfma_f32_16x16x32_bf16 v[48:51], a[124:127], a[40:43], v[48:51]
    ds_read_b64_tr_b16 a[192:193], v8 offset:33792
    v_cvt_pk_bf16_f32 v85, v222, v223
    v_mfma_f32_16x16x32_bf16 v[52:55], a[124:127], a[44:47], v[52:55]
    ds_read_b64_tr_b16 a[194:195], v8 offset:42240
    v_cvt_pk_bf16_f32 v86, v232, v233
    v_mfma_f32_16x16x32_bf16 v[32:35], a[128:131], a[48:51], v[32:35]
    s_add_u32 m0, s38, 84480
    v_cvt_pk_bf16_f32 v87, v234, v235
    v_mfma_f32_16x16x32_bf16 v[36:39], a[128:131], a[52:55], v[36:39]
    buffer_load_dwordx4 v4, s[12:15], s33 offen nt lds
    v_mfma_f32_16x16x32_bf16 v[40:43], a[128:131], a[56:59], v[40:43]
    ds_read_b64_tr_b16 a[196:197], v8 offset:33824
    ds_read_b64_tr_b16 a[198:199], v8 offset:42272
    v_mfma_f32_16x16x32_bf16 v[44:47], a[132:135], a[48:51], v[44:47]
    ds_write_b128 v9, v[84:87] offset:1024
    v_mfma_f32_16x16x32_bf16 v[48:51], a[132:135], a[52:55], v[48:51]
    ds_read_b64_tr_b16 a[200:201], v8 offset:33856
    ds_read_b64_tr_b16 a[202:203], v8 offset:42304
    v_mfma_f32_16x16x32_bf16 v[52:55], a[132:135], a[56:59], v[52:55]
    s_add_u32 m0, s38, 86656
    ds_read_b64_tr_b16 a[204:205], v8 offset:33888
    v_mfma_f32_16x16x32_bf16 v[32:35], a[136:139], a[60:63], v[32:35]
    buffer_load_dwordx4 v4, s[12:15], s33 offen offset:2048 nt lds
    v_mfma_f32_16x16x32_bf16 v[36:39], a[136:139], a[64:67], v[36:39]
    v_exp_f32 v225, v65
    v_mfma_f32_16x16x32_bf16 v[40:43], a[136:139], a[68:71], v[40:43]
    v_exp_f32 v226, v66
    v_mfma_f32_16x16x32_bf16 v[44:47], a[140:143], a[60:63], v[44:47]
    v_exp_f32 v227, v67
    v_mfma_f32_16x16x32_bf16 v[48:51], a[140:143], a[64:67], v[48:51]
    ds_read_b64_tr_b16 a[206:207], v8 offset:42336
    ds_read_b64_tr_b16 a[208:209], v8 offset:33920
    v_mfma_f32_16x16x32_bf16 v[52:55], a[140:143], a[68:71], v[52:55]
    s_add_u32 m0, s38, 92928
    ds_read_b64_tr_b16 a[210:211], v8 offset:42368
    v_mfma_f32_16x16x32_bf16 v[32:35], a[144:147], a[72:75], v[32:35]
    v_exp_f32 v236, v76
    buffer_load_dwordx4 v5, s[12:15], s33 offen nt lds
    v_mfma_f32_16x16x32_bf16 v[36:39], a[144:147], a[76:79], v[36:39]
    v_exp_f32 v237, v77
    v_mfma_f32_16x16x32_bf16 v[40:43], a[144:147], a[80:83], v[40:43]
    ds_read_b64_tr_b16 a[212:213], v8 offset:33952
    ds_read_b64_tr_b16 a[214:215], v8 offset:42400
    v_mfma_f32_16x16x32_bf16 v[44:47], a[148:151], a[72:75], v[44:47]
    v_exp_f32 v238, v78
    v_mfma_f32_16x16x32_bf16 v[48:51], a[148:151], a[76:79], v[48:51]
    v_exp_f32 v239, v79
    v_mfma_f32_16x16x32_bf16 v[52:55], a[148:151], a[80:83], v[52:55]
    ds_read_b64_tr_b16 a[216:217], v8 offset:33984
    ds_read_b64_tr_b16 a[218:219], v8 offset:42432
    ds_read_b64_tr_b16 a[220:221], v8 offset:34016
    ds_read_b64_tr_b16 a[222:223], v8 offset:42464
    s_add_u32 m0, s38, 95104
    v_mfma_f32_16x16x32_bf16 v[32:35], a[152:155], a[84:87], v[32:35]
    v_cvt_pk_bf16_f32 v88, v224, v225
    buffer_load_dwordx4 v5, s[12:15], s33 offen offset:2048 nt lds
    v_mfma_f32_16x16x32_bf16 v[36:39], a[152:155], a[88:91], v[36:39]
    v_cvt_pk_bf16_f32 v89, v226, v227
    v_cvt_pk_bf16_f32 v90, v236, v237
    v_cvt_pk_bf16_f32 v91, v238, v239
    ds_write_b128 v9, v[88:91] offset:2048
    v_mfma_f32_16x16x32_bf16 v[40:43], a[152:155], a[92:95], v[40:43]
    v_mfma_f32_16x16x32_bf16 v[44:47], a[156:159], a[84:87], v[44:47]
    v_mfma_f32_16x16x32_bf16 v[48:51], a[156:159], a[88:91], v[48:51]
    s_add_u32 s33, s33, 32768
    v_mfma_f32_16x16x32_bf16 v[52:55], a[156:159], a[92:95], v[52:55]
    s_waitcnt vmcnt(8) lgkmcnt(0)
    s_barrier
    v_mfma_f32_16x16x32_bf16 v[120:123], a[160:163], v[80:83], v[120:123]
    ds_read_b128 v[92:95], v10 offset:0
    ds_read_b128 v[96:99], v10 offset:1024
    v_mfma_f32_16x16x32_bf16 v[124:127], a[160:163], v[84:87], v[124:127]
    s_add_u32 m0, s38, 0
    ds_read_b128 v[100:103], v10 offset:2048
    v_mfma_f32_16x16x32_bf16 v[128:131], a[160:163], v[88:91], v[128:131]
    buffer_load_dwordx4 v2, s[8:11], s32 offen nt lds
    v_mfma_f32_16x16x32_bf16 v[132:135], a[164:167], v[80:83], v[132:135]
    v_fma_f32 v56, v32, s36, -v16
    v_fma_f32 v57, v33, s36, -v16
    v_mfma_f32_16x16x32_bf16 v[136:139], a[164:167], v[84:87], v[136:139]
    ds_read_b128 a[96:99], v6 offset:33792
    v_fma_f32 v58, v34, s36, -v16
    v_mfma_f32_16x16x32_bf16 v[140:143], a[164:167], v[88:91], v[140:143]
    v_fma_f32 v59, v35, s36, -v16
    v_fma_f32 v68, v44, s36, -v16
    v_mfma_f32_16x16x32_bf16 v[144:147], a[168:171], v[80:83], v[144:147]
    ds_read_b128 a[100:103], v6 offset:42240
    v_fma_f32 v69, v45, s36, -v16
    v_mfma_f32_16x16x32_bf16 v[148:151], a[168:171], v[84:87], v[148:151]
    s_add_u32 m0, s38, 2176
    v_fma_f32 v70, v46, s36, -v16
    v_mfma_f32_16x16x32_bf16 v[152:155], a[168:171], v[88:91], v[152:155]
    buffer_load_dwordx4 v2, s[8:11], s32 offen offset:2048 nt lds
    v_mfma_f32_16x16x32_bf16 v[156:159], a[172:175], v[80:83], v[156:159]
    v_fma_f32 v71, v47, s36, -v16
    v_fma_f32 v60, v36, s36, -v17
    v_mfma_f32_16x16x32_bf16 v[160:163], a[172:175], v[84:87], v[160:163]
    ds_read_b128 a[104:107], v6 offset:33856
    v_max3_f32 v19, v56, v57, v58
    v_mfma_f32_16x16x32_bf16 v[164:167], a[172:175], v[88:91], v[164:167]
    v_max3_f32 v19, v19, v59, v68
    v_max3_f32 v19, v19, v69, v70
    v_mfma_f32_16x16x32_bf16 v[168:171], a[176:179], v[80:83], v[168:171]
    ds_read_b128 a[108:111], v6 offset:42304
    v_max3_f32 v19, v19, v71, v60
    v_mfma_f32_16x16x32_bf16 v[172:175], a[176:179], v[84:87], v[172:175]
    v_fma_f32 v61, v37, s36, -v17
    v_fma_f32 v62, v38, s36, -v17
    v_mfma_f32_16x16x32_bf16 v[176:179], a[176:179], v[88:91], v[176:179]
    s_add_u32 m0, s38, 8448
    v_fma_f32 v63, v39, s36, -v17
    v_mfma_f32_16x16x32_bf16 v[180:183], a[180:183], v[80:83], v[180:183]
    buffer_load_dwordx4 v3, s[8:11], s32 offen nt lds
    v_mfma_f32_16x16x32_bf16 v[184:187], a[180:183], v[84:87], v[184:187]
    ds_read_b128 a[112:115], v6 offset:33920
    v_fma_f32 v72, v48, s36, -v17
    v_mfma_f32_16x16x32_bf16 v[188:191], a[180:183], v[88:91], v[188:191]
    v_fma_f32 v73, v49, s36, -v17
    v_fma_f32 v74, v50, s36, -v17
    v_mfma_f32_16x16x32_bf16 v[192:195], a[184:187], v[80:83], v[192:195]
    v_fma_f32 v75, v51, s36, -v17
    ds_read_b128 a[116:119], v6 offset:42368
    v_mfma_f32_16x16x32_bf16 v[196:199], a[184:187], v[84:87], v[196:199]
    v_fma_f32 v64, v40, s36, -v18
    v_max3_f32 v19, v19, v61, v62
    v_mfma_f32_16x16x32_bf16 v[200:203], a[184:187], v[88:91], v[200:203]
    s_add_u32 m0, s38, 10624
    v_max3_f32 v19, v19, v63, v72
    v_mfma_f32_16x16x32_bf16 v[204:207], a[188:191], v[80:83], v[204:207]
    buffer_load_dwordx4 v3, s[8:11], s32 offen offset:2048 nt lds
    v_mfma_f32_16x16x32_bf16 v[208:211], a[188:191], v[84:87], v[208:211]
    ds_read_b128 a[120:123], v6 offset:33984
    v_max3_f32 v19, v19, v73, v74
    v_mfma_f32_16x16x32_bf16 v[212:215], a[188:191], v[88:91], v[212:215]
    v_max3_f32 v19, v19, v75, v64
    v_fma_f32 v65, v41, s36, -v18
    v_mfma_f32_16x16x32_bf16 v[104:107], v[116:119], v[80:83], v[104:107]
    v_fma_f32 v66, v42, s36, -v18
    ds_read_b128 a[124:127], v6 offset:42432
    v_mfma_f32_16x16x32_bf16 v[108:111], v[116:119], v[84:87], v[108:111]
    v_fma_f32 v67, v43, s36, -v18
    v_fma_f32 v76, v52, s36, -v18
    v_mfma_f32_16x16x32_bf16 v[112:115], v[116:119], v[88:91], v[112:115]
    v_fma_f32 v77, v53, s36, -v18
    ds_read_b128 a[128:131], v6 offset:34048
    s_waitcnt lgkmcnt(11)
    v_mfma_f32_16x16x32_bf16 v[120:123], a[192:195], v[92:95], v[120:123]
    s_add_u32 m0, s38, 16896
    v_fma_f32 v78, v54, s36, -v18
    s_waitcnt lgkmcnt(10)
    v_mfma_f32_16x16x32_bf16 v[124:127], a[192:195], v[96:99], v[124:127]
    buffer_load_dwordx4 v4, s[8:11], s32 offen nt lds
    s_waitcnt lgkmcnt(9)
    v_mfma_f32_16x16x32_bf16 v[128:131], a[192:195], v[100:103], v[128:131]
    v_fma_f32 v79, v55, s36, -v18
    v_max3_f32 v19, v19, v65, v66
    v_mfma_f32_16x16x32_bf16 v[132:135], a[196:199], v[92:95], v[132:135]
    v_max3_f32 v19, v19, v67, v76
    ds_read_b128 a[132:135], v6 offset:42496
    v_mfma_f32_16x16x32_bf16 v[136:139], a[196:199], v[96:99], v[136:139]
    v_max3_f32 v19, v19, v77, v78
    v_max_f32 v19, v19, v79
    v_mfma_f32_16x16x32_bf16 v[140:143], a[196:199], v[100:103], v[140:143]
    v_cmp_lt_f32 vcc, s37, v19
    ds_read_b128 a[136:139], v6 offset:34112
    v_mfma_f32_16x16x32_bf16 v[144:147], a[200:203], v[92:95], v[144:147]
    s_add_u32 m0, s38, 19072
    ds_read_b128 a[140:143], v6 offset:42560
    v_mfma_f32_16x16x32_bf16 v[148:151], a[200:203], v[96:99], v[148:151]
    buffer_load_dwordx4 v4, s[8:11], s32 offen offset:2048 nt lds
    v_mfma_f32_16x16x32_bf16 v[152:155], a[200:203], v[100:103], v[152:155]
    v_exp_f32 v216, v56
    v_mfma_f32_16x16x32_bf16 v[156:159], a[204:207], v[92:95], v[156:159]
    v_exp_f32 v217, v57
    v_mfma_f32_16x16x32_bf16 v[160:163], a[204:207], v[96:99], v[160:163]
    v_exp_f32 v218, v58
    v_mfma_f32_16x16x32_bf16 v[164:167], a[204:207], v[100:103], v[164:167]
    v_exp_f32 v219, v59
    v_mfma_f32_16x16x32_bf16 v[168:171], a[208:211], v[92:95], v[168:171]
    ds_read_b128 a[144:147], v6 offset:34176
    ds_read_b128 a[148:151], v6 offset:42624
    v_mfma_f32_16x16x32_bf16 v[172:175], a[208:211], v[96:99], v[172:175]
    s_add_u32 m0, s38, 25344
    ds_read_b128 a[152:155], v6 offset:34240
    v_mfma_f32_16x16x32_bf16 v[176:179], a[208:211], v[100:103], v[176:179]
    v_exp_f32 v228, v68
    buffer_load_dwordx4 v5, s[8:11], s32 offen nt lds
    v_mfma_f32_16x16x32_bf16 v[180:183], a[212:215], v[92:95], v[180:183]
    v_exp_f32 v229, v69
    v_mfma_f32_16x16x32_bf16 v[184:187], a[212:215], v[96:99], v[184:187]
    v_exp_f32 v230, v70
    v_mfma_f32_16x16x32_bf16 v[188:191], a[212:215], v[100:103], v[188:191]
    v_exp_f32 v231, v71
    v_mfma_f32_16x16x32_bf16 v[192:195], a[216:219], v[92:95], v[192:195]
    v_exp_f32 v220, v60
    v_mfma_f32_16x16x32_bf16 v[196:199], a[216:219], v[96:99], v[196:199]
    ds_read_b128 a[156:159], v6 offset:42688
    s_add_u32 m0, s38, 27520
    v_mfma_f32_16x16x32_bf16 v[200:203], a[216:219], v[100:103], v[200:203]
    buffer_load_dwordx4 v5, s[8:11], s32 offen offset:2048 nt lds
    v_mfma_f32_16x16x32_bf16 v[204:207], a[220:223], v[92:95], v[204:207]
    v_exp_f32 v221, v61
    v_mfma_f32_16x16x32_bf16 v[208:211], a[220:223], v[96:99], v[208:211]
    v_exp_f32 v222, v62
    v_mfma_f32_16x16x32_bf16 v[212:215], a[220:223], v[100:103], v[212:215]
    v_exp_f32 v223, v63
    v_mfma_f32_16x16x32_bf16 v[104:107], v[116:119], v[92:95], v[104:107]
    v_exp_f32 v232, v72
    v_mfma_f32_16x16x32_bf16 v[108:111], v[116:119], v[96:99], v[108:111]
    v_exp_f32 v233, v73
    s_cbranch_vccnz L_sf1
L_sb1:
    s_add_u32 s32, s32, 32768
    v_mfma_f32_16x16x32_bf16 v[112:115], v[116:119], v[100:103], v[112:115]
    s_waitcnt vmcnt(8) lgkmcnt(0)
    s_barrier
    ds_read_b32 v20, v14
    v_mfma_f32_16x16x32_bf16 v[32:35], a[96:99], a[0:3], 0
    ds_read_b64_tr_b16 a[160:161], v7 offset:0
    ds_read_b64_tr_b16 a[162:163], v7 offset:8448
    v_mfma_f32_16x16x32_bf16 v[36:39], a[96:99], a[4:7], 0
    s_add_u32 m0, s38, 101376
    ds_read_b64_tr_b16 a[164:165], v7 offset:32
    v_mfma_f32_16x16x32_bf16 v[40:43], a[96:99], a[8:11], 0
    buffer_load_dwordx4 v2, s[12:15], s33 offen nt lds
    v_mfma_f32_16x16x32_bf16 v[44:47], a[100:103], a[0:3], 0
    ds_read_b64_tr_b16 a[166:167], v7 offset:8480
    ds_read_b64_tr_b16 a[168:169], v7 offset:64
    v_mfma_f32_16x16x32_bf16 v[48:51], a[100:103], a[4:7], 0
    ds_read_b64_tr_b16 a[170:171], v7 offset:8512
    ds_read_b64_tr_b16 a[172:173], v7 offset:96
    v_mfma_f32_16x16x32_bf16 v[52:55], a[100:103], a[8:11], 0
    ds_read_b64_tr_b16 a[174:175], v7 offset:8544
    ds_read_b64_tr_b16 a[176:177], v7 offset:128
    v_mfma_f32_16x16x32_bf16 v[32:35], a[104:107], a[12:15], v[32:35]
    s_add_u32 m0, s38, 103552
    ds_read_b64_tr_b16 a[178:179], v7 offset:8576
    v_mfma_f32_16x16x32_bf16 v[36:39], a[104:107], a[16:19], v[36:39]
    s_waitcnt lgkmcnt(10)
    v_readfirstlane_b32 s45, v20
    buffer_load_dwordx4 v2, s[12:15], s33 offen offset:2048 nt lds
    v_mfma_f32_16x16x32_bf16 v[40:43], a[104:107], a[20:23], v[40:43]
    ds_read_b64_tr_b16 a[180:181], v7 offset:160
    v_mfma_f32_16x16x32_bf16 v[44:47], a[108:111], a[12:15], v[44:47]
    s_cmp_eq_u32 s45, 0
    s_cbranch_scc0 L_call1
L_back1:
    v_mfma_f32_16x16x32_bf16 v[48:51], a[108:111], a[16:19], v[48:51]
    v_cvt_pk_bf16_f32 v80, v216, v217
    v_cvt_pk_bf16_f32 v81, v218, v219
    v_mfma_f32_16x16x32_bf16 v[52:55], a[108:111], a[20:23], v[52:55]
    v_cvt_pk_bf16_f32 v82, v228, v229
    v_cvt_pk_bf16_f32 v83, v230, v231
    v_mfma_f32_16x16x32_bf16 v[32:35], a[112:115], a[24:27], v[32:35]
    s_add_u32 m0, s38, 109824
    ds_read_b64_tr_b16 a[182:183], v7 offset:8608
    v_mfma_f32_16x16x32_bf16 v[36:39], a[112:115], a[28:31], v[36:39]
    buffer_load_dwordx4 v3, s[12:15], s33 offen nt lds
    v_mfma_f32_16x16x32_bf16 v[40:43], a[112:115], a[32:35], v[40:43]
    ds_write_b128 v9, v[80:83] offset:0
    v_mfma_f32_16x16x32_bf16 v[44:47], a[116:119], a[24:27], v[44:47]
    ds_read_b64_tr_b16 a[184:185], v7 offset:192
    ds_read_b64_tr_b16 a[186:187], v7 offset:8640
    v_mfma_f32_16x16x32_bf16 v[48:51], a[116:119], a[28:31], v[48:51]
    v_exp_f32 v234, v74
    v_mfma_f32_16x16x32_bf16 v[52:55], a[116:119], a[32:35], v[52:55]
    v_exp_f32 v235, v75
    v_mfma_f32_16x16x32_bf16 v[32:35], a[120:123], a[36:39], v[32:35]
    s_add_u32 m0, s38, 112000
    ds_read_b64_tr_b16 a[188:189], v7 offset:224
    v_mfma_f32_16x16x32_bf16 v[36:39], a[120:123], a[40:43], v[36:39]
    buffer_load_dwordx4 v3, s[12:15], s33 offen offset:2048 nt lds
    v_mfma_f32_16x16x32_bf16 v[40:43], a[120:123], a[44:47], v[40:43]
    v_exp_f32 v224, v64
    v_mfma_f32_16x16x32_bf16 v[44:47], a[124:127], a[36:39], v[44:47]
    ds_read_b64_tr_b16 a[190:191], v7 offset:8672
    v_cvt_pk_bf16_f32 v84, v220, v221
    v_mfma_f32_16x16x32_bf16 v[48:51], a[124:127], a[40:43], v[48:51]
    ds_read_b64_tr_b16 a[192:193], v8 offset:0
    v_cvt_pk_bf16_f32 v85, v222, v223
    v_mfma_f32_16x16x32_bf16 v[52:55], a[124:127], a[44:47], v[52:55]
    ds_read_b64_tr_b16 a[194:195], v8 offset:8448
    v_cvt_pk_bf16_f32 v86, v232, v233
    v_mfma_f32_16x16x32_bf16 v[32:35], a[128:131], a[48:51], v[32:35]
    s_add_u32 m0, s38, 118272
    v_cvt_pk_bf16_f32 v87, v234, v235
    v_mfma_f32_16x16x32_bf16 v[36:39], a[128:131], a[52:55], v[36:39]
    buffer_load_dwordx4 v4, s[12:15], s33 offen nt lds
    v_mfma_f32_16x16x32_bf16 v[40:43], a[128:131], a[56:59], v[40:43]
    ds_read_b64_tr_b16 a[196:197], v8 offset:32
    ds_read_b64_tr_b16 a[198:199], v8 offset:8480
    v_mfma_f32_16x16x32_bf16 v[44:47], a[132:135], a[48:51], v[44:47]
    ds_write_b128 v9, v[84:87] offset:1024
    v_mfma_f32_16x16x32_bf16 v[48:51], a[132:135], a[52:55], v[48:51]
    ds_read_b64_tr_b16 a[200:201], v8 offset:64
    ds_read_b64_tr_b16 a[202:203], v8 offset:8512
    v_mfma_f32_16x16x32_bf16 v[52:55], a[132:135], a[56:59], v[52:55]
    s_add_u32 m0, s38, 120448
    ds_read_b64_tr_b16 a[204:205], v8 offset:96
    v_mfma_f32_16x16x32_bf16 v[32:35], a[136:139], a[60:63], v[32:35]
    buffer_load_dwordx4 v4, s[12:15], s33 offen offset:2048 nt lds
    v_mfma_f32_16x16x32_bf16 v[36:39], a[136:139], a[64:67], v[36:39]
    v_exp_f32 v225, v65
    v_mfma_f32_16x16x32_bf16 v[40:43], a[136:139], a[68:71], v[40:43]
    v_exp_f32 v226, v66
    v_mfma_f32_16x16x32_bf16 v[44:47], a[140:143], a[60:63], v[44:47]
    v_exp_f32 v227, v67
    v_mfma_f32_16x16x32_bf16 v[48:51], a[140:143], a[64:67], v[48:51]
    ds_read_b64_tr_b16 a[206:207], v8 offset:8544
    ds_read_b64_tr_b16 a[208:209], v8 offset:128
    v_mfma_f32_16x16x32_bf16 v[52:55], a[140:143], a[68:71], v[52:55]
    s_add_u32 m0, s38, 126720
    ds_read_b64_tr_b16 a[210:211], v8 offset:8576
    v_mfma_f32_16x16x32_bf16 v[32:35], a[144:147], a[72:75], v[32:35]
    v_exp_f32 v236, v76
    buffer_load_dwordx4 v5, s[12:15], s33 offen nt lds
    v_mfma_f32_16x16x32_bf16 v[36:39], a[144:147], a[76:79], v[36:39]
    v_exp_f32 v237, v77
    v_mfma_f32_16x16x32_bf16 v[40:43], a[144:147], a[80:83], v[40:43]
    ds_read_b64_tr_b16 a[212:213], v8 offset:160
    ds_read_b64_tr_b16 a[214:215], v8 offset:8608
    v_mfma_f32_16x16x32_bf16 v[44:47], a[148:151], a[72:75], v[44:47]
    v_exp_f32 v238, v78
    v_mfma_f32_16x16x32_bf16 v[48:51], a[148:151], a[76:79], v[48:51]
    v_exp_f32 v239, v79
    v_mfma_f32_16x16x32_bf16 v[52:55], a[148:151], a[80:83], v[52:55]
    ds_read_b64_tr_b16 a[216:217], v8 offset:192
    ds_read_b64_tr_b16 a[218:219], v8 offset:8640
    ds_read_b64_tr_b16 a[220:221], v8 offset:224
    ds_read_b64_tr_b16 a[222:223], v8 offset:8672
    s_add_u32 m0, s38, 128896
    v_mfma_f32_16x16x32_bf16 v[32:35], a[152:155], a[84:87], v[32:35]
    v_cvt_pk_bf16_f32 v88, v224, v225
    buffer_load_dwordx4 v5, s[12:15], s33 offen offset:2048 nt lds
    v_mfma_f32_16x16x32_bf16 v[36:39], a[152:155], a[88:91], v[36:39]
    v_cvt_pk_bf16_f32 v89, v226, v227
    v_cvt_pk_bf16_f32 v90, v236, v237
    v_cvt_pk_bf16_f32 v91, v238, v239
    ds_write_b128 v9, v[88:91] offset:2048
    v_mfma_f32_16x16x32_bf16 v[40:43], a[152:155], a[92:95], v[40:43]
    v_mfma_f32_16x16x32_bf16 v[44:47], a[156:159], a[84:87], v[44:47]
    v_mfma_f32_16x16x32_bf16 v[48:51], a[156:159], a[88:91], v[48:51]
    s_add_u32 s33, s33, 32768
    v_mfma_f32_16x16x32_bf16 v[52:55], a[156:159], a[92:95], v[52:55]
    s_waitcnt vmcnt(8) lgkmcnt(0)
    s_barrier
    v_mfma_f32_16x16x32_bf16 v[120:123], a[160:163], v[80:83], v[120:123]
    ds_read_b128 v[92:95], v10 offset:0
    ds_read_b128 v[96:99], v10 offset:1024
    v_mfma_f32_16x16x32_bf16 v[124:127], a[160:163], v[84:87], v[124:127]
    s_add_u32 m0, s38, 33792
    ds_read_b128 v[100:103], v10 offset:2048
    v_mfma_f32_16x16x32_bf16 v[128:131], a[160:163], v[88:91], v[128:131]
    buffer_load_dwordx4 v2, s[8:11], s32 offen nt lds
    v_mfma_f32_16x16x32_bf16 v[132:135], a[164:167], v[80:83], v[132:135]
    v_fma_f32 v56, v32, s36, -v16
    v_fma_f32 v57, v33, s36, -v16
    v_mfma_f32_16x16x32_bf16 v[136:139], a[164:167], v[84:87], v[136:139]
    ds_read_b128 a[96:99], v6 offset:0
    v_fma_f32 v58, v34, s36, -v16
    v_mfma_f32_16x16x32_bf16 v[140:143], a[164:167], v[88:91], v[140:143]
    v_fma_f32 v59, v35, s36, -v16
    v_fma_f32 v68, v44, s36, -v16
    v_mfma_f32_16x16x32_bf16 v[144:147], a[168:171], v[80:83], v[144:147]
    ds_read_b128 a[100:103], v6 offset:8448
    v_fma_f32 v69, v45, s36, -v16
    v_mfma_f32_16x16x32_bf16 v[148:151], a[168:171], v[84:87], v[148:151]
    s_add_u32 m0, s38, 35968
    v_fma_f32 v70, v46, s36, -v16
    v_mfma_f32_16x16x32_bf16 v[152:155], a[168:171], v[88:91], v[152:155]
    buffer_load_dwordx4 v2, s[8:11], s32 offen offset:2048 nt lds
    v_mfma_f32_16x16x32_bf16 v[156:159], a[172:175], v[80:83], v[156:159]
    v_fma_f32 v71, v47, s36, -v16
    v_fma_f32 v60, v36, s36, -v17
    v_mfma_f32_16x16x32_bf16 v[160:163], a[172:175], v[84:87], v[160:163]
    ds_read_b128 a[104:107], v6 offset:64
    v_max3_f32 v19, v56, v57, v58
    v_mfma_f32_16x16x32_bf16 v[164:167], a[172:175], v[88:91], v[164:167]
    v_max3_f32 v19, v19, v59, v68
    v_max3_f32 v19, v19, v69, v70
    v_mfma_f32_16x16x32_bf16 v[168:171], a[176:179], v[80:83], v[168:171]
    ds_read_b128 a[108:111], v6 offset:8512
    v_max3_f32 v19, v19, v71, v60
    v_mfma_f32_16x16x32_bf16 v[172:175], a[176:179], v[84:87], v[172:175]
    v_fma_f32 v61, v37, s36, -v17
    v_fma_f32 v62, v38, s36, -v17
    v_mfma_f32_16x16x32_bf16 v[176:179], a[176:179], v[88:91], v[176:179]
    s_add_u32 m0, s38, 42240
    v_fma_f32 v63, v39, s36, -v17
    v_mfma_f32_16x16x32_bf16 v[180:183], a[180:183], v[80:83], v[180:183]
    buffer_load_dwordx4 v3, s[8:11], s32 offen nt lds
    v_mfma_f32_16x16x32_bf16 v[184:187], a[180:183], v[84:87], v[184:187]
    ds_read_b128 a[112:115], v6 offset:128
    v_fma_f32 v72, v48, s36, -v17
    v_mfma_f32_16x16x32_bf16 v[188:191], a[180:183], v[88:91], v[188:191]
    v_fma_f32 v73, v49, s36, -v17
    v_fma_f32 v74, v50, s36, -v17
    v_mfma_f32_16x16x32_bf16 v[192:195], a[184:187], v[80:83], v[192:195]
    v_fma_f32 v75, v51, s36, -v17
    ds_read_b128 a[116:119], v6 offset:8576
    v_mfma_f32_16x16x32_bf16 v[196:199], a[184:187], v[84:87], v[196:199]
    v_fma_f32 v64, v40, s36, -v18
    v_max3_f32 v19, v19, v61, v62
    v_mfma_f32_16x16x32_bf16 v[200:203], a[184:187], v[88:91], v[200:203]
    s_add_u32 m0, s38, 44416
    v_max3_f32 v19, v19, v63, v72
    v_mfma_f32_16x16x32_bf16 v[204:207], a[188:191], v[80:83], v[204:207]
    buffer_load_dwordx4 v3, s[8:11], s32 offen offset:2048 nt lds
    v_mfma_f32_16x16x32_bf16 v[208:211], a[188:191], v[84:87], v[208:211]
    ds_read_b128 a[120:123], v6 offset:192
    v_max3_f32 v19, v19, v73, v74
    v_mfma_f32_16x16x32_bf16 v[212:215], a[188:191], v[88:91], v[212:215]
    v_max3_f32 v19, v19, v75, v64
    v_fma_f32 v65, v41, s36, -v18
    v_mfma_f32_16x16x32_bf16 v[104:107], v[116:119], v[80:83], v[104:107]
    v_fma_f32 v66, v42, s36, -v18
    ds_read_b128 a[124:127], v6 offset:8640
    v_mfma_f32_16x16x32_bf16 v[108:111], v[116:119], v[84:87], v[108:111]
    v_fma_f32 v67, v43, s36, -v18
    v_fma_f32 v76, v52, s36, -v18
    v_mfma_f32_16x16x32_bf16 v[112:115], v[116:119], v[88:91], v[112:115]
    v_fma_f32 v77, v53, s36, -v18
    ds_read_b128 a[128:131], v6 offset:256
    s_waitcnt lgkmcnt(11)
    v_mfma_f32_16x16x32_bf16 v[120:123], a[192:195], v[92:95], v[120:123]
    s_add_u32 m0, s38, 50688
    v_fma_f32 v78, v54, s36, -v18
    s_waitcnt lgkmcnt(10)
    v_mfma_f32_16x16x32_bf16 v[124:127], a[192:195], v[96:99], v[124:127]
    buffer_load_dwordx4 v4, s[8:11], s32 offen nt lds
    s_waitcnt lgkmcnt(9)
    v_mfma_f32_16x16x32_bf16 v[128:131], a[192:195], v[100:103], v[128:131]
    v_fma_f32 v79, v55, s36, -v18
    v_max3_f32 v19, v19, v65, v66
    v_mfma_f32_16x16x32_bf16 v[132:135], a[196:199], v[92:95], v[132:135]
    v_max3_f32 v19, v19, v67, v76
    ds_read_b128 a[132:135], v6 offset:8704
    v_mfma_f32_16x16x32_bf16 v[136:139], a[196:199], v[96:99], v[136:139]
    v_max3_f32 v19, v19, v77, v78
    v_max_f32 v19, v19, v79
    v_mfma_f32_16x16x32_bf16 v[140:143], a[196:199], v[100:103], v[140:143]
    v_cmp_lt_f32 vcc, s37, v19
    ds_read_b128 a[136:139], v6 offset:320
    v_mfma_f32_16x16x32_bf16 v[144:147], a[200:203], v[92:95], v[144:147]
    s_add_u32 m0, s38, 52864
    ds_read_b128 a[140:143], v6 offset:8768
    v_mfma_f32_16x16x32_bf16 v[148:151], a[200:203], v[96:99], v[148:151]
    buffer_load_dwordx4 v4, s[8:11], s32 offen offset:2048 nt lds
    v_mfma_f32_16x16x32_bf16 v[152:155], a[200:203], v[100:103], v[152:155]
    v_exp_f32 v216, v56
    v_mfma_f32_16x16x32_bf16 v[156:159], a[204:207], v[92:95], v[156:159]
    v_exp_f32 v217, v57
    v_mfma_f32_16x16x32_bf16 v[160:163], a[204:207], v[96:99], v[160:163]
    v_exp_f32 v218, v58
    v_mfma_f32_16x16x32_bf16 v[164:167], a[204:207], v[100:103], v[164:167]
    v_exp_f32 v219, v59
    v_mfma_f32_16x16x32_bf16 v[168:171], a[208:211], v[92:95], v[168:171]
    ds_read_b128 a[144:147], v6 offset:384
    ds_read_b128 a[148:151], v6 offset:8832
    v_mfma_f32_16x16x32_bf16 v[172:175], a[208:211], v[96:99], v[172:175]
    s_add_u32 m0, s38, 59136
    ds_read_b128 a[152:155], v6 offset:448
    v_mfma_f32_16x16x32_bf16 v[176:179], a[208:211], v[100:103], v[176:179]
    v_exp_f32 v228, v68
    buffer_load_dwordx4 v5, s[8:11], s32 offen nt lds
    v_mfma_f32_16x16x32_bf16 v[180:183], a[212:215], v[92:95], v[180:183]
    v_exp_f32 v229, v69
    v_mfma_f32_16x16x32_bf16 v[184:187], a[212:215], v[96:99], v[184:187]
    v_exp_f32 v230, v70
    v_mfma_f32_16x16x32_bf16 v[188:191], a[212:215], v[100:103], v[188:191]
    v_exp_f32 v231, v71
    v_mfma_f32_16x16x32_bf16 v[192:195], a[216:219], v[92:95], v[192:195]
    v_exp_f32 v220, v60
    v_mfma_f32_16x16x32_bf16 v[196:199], a[216:219], v[96:99], v[196:199]
    ds_read_b128 a[156:159], v6 offset:8896
    s_add_u32 m0, s38, 61312
    v_mfma_f32_16x16x32_bf16 v[200:203], a[216:219], v[100:103], v[200:203]
    buffer_load_dwordx4 v5, s[8:11], s32 offen offset:2048 nt lds
    v_mfma_f32_16x16x32_bf16 v[204:207], a[220:223], v[92:95], v[204:207]
    v_exp_f32 v221, v61
    v_mfma_f32_16x16x32_bf16 v[208:211], a[220:223], v[96:99], v[208:211]
    v_exp_f32 v222, v62
    v_mfma_f32_16x16x32_bf16 v[212:215], a[220:223], v[100:103], v[212:215]
    v_exp_f32 v223, v63
    v_mfma_f32_16x16x32_bf16 v[104:107], v[116:119], v[92:95], v[104:107]
    v_exp_f32 v232, v72
    v_mfma_f32_16x16x32_bf16 v[108:111], v[116:119], v[96:99], v[108:111]
    v_exp_f32 v233, v73
    s_cbranch_vccnz L_sf2
L_sb2:
    s_add_u32 s32, s32, 32768
    v_mfma_f32_16x16x32_bf16 v[112:115], v[116:119], v[100:103], v[112:115]
    s_add_u32 s39, s39, 1
    s_cmp_lt_u32 s39, 6
    s_cbranch_scc1 L_loop
    s_mov_b32 s47, s44
    s_waitcnt vmcnt(8) lgkmcnt(0)
    s_barrier
    ds_read_b32 v20, v14
    v_mfma_f32_16x16x32_bf16 v[32:35], a[96:99], a[0:3], 0
    ds_read_b64_tr_b16 a[160:161], v7 offset:33792
    ds_read_b64_tr_b16 a[162:163], v7 offset:42240
    v_mfma_f32_16x16x32_bf16 v[36:39], a[96:99], a[4:7], 0
    s_add_u32 m0, s38, 67584
    ds_read_b64_tr_b16 a[164:165], v7 offset:33824
    v_mfma_f32_16x16x32_bf16 v[40:43], a[96:99], a[8:11], 0
    buffer_load_dwordx4 v2, s[12:15], s33 offen nt lds
    v_mfma_f32_16x16x32_bf16 v[44:47], a[100:103], a[0:3], 0
    ds_read_b64_tr_b16 a[166:167], v7 offset:42272
    ds_read_b64_tr_b16 a[168:169], v7 offset:33856
    v_mfma_f32_16x16x32_bf16 v[48:51], a[100:103], a[4:7], 0
    ds_read_b64_tr_b16 a[170:171], v7 offset:42304
    ds_read_b64_tr_b16 a[172:173], v7 offset:33888
    v_mfma_f32_16x16x32_bf16 v[52:55], a[100:103], a[8:11], 0
    ds_read_b64_tr_b16 a[174:175], v7 offset:42336
    ds_read_b64_tr_b16 a[176:177], v7 offset:33920
    v_mfma_f32_16x16x32_bf16 v[32:35], a[104:107], a[12:15], v[32:35]
    s_add_u32 m0, s38, 69760
    ds_read_b64_tr_b16 a[178:179], v7 offset:42368
    v_mfma_f32_16x16x32_bf16 v[36:39], a[104:107], a[16:19], v[36:39]
    s_waitcnt lgkmcnt(10)
    v_readfirstlane_b32 s45, v20
    buffer_load_dwordx4 v2, s[12:15], s33 offen offset:2048 nt lds
    v_mfma_f32_16x16x32_bf16 v[40:43], a[104:107], a[20:23], v[40:43]
    ds_read_b64_tr_b16 a[180:181], v7 offset:33952
    v_mfma_f32_16x16x32_bf16 v[44:47], a[108:111], a[12:15], v[44:47]
    s_cmp_eq_u32 s45, 0
    s_cbranch_scc0 L_call2
L_back2:
    v_mfma_f32_16x16x32_bf16 v[48:51], a[108:111], a[16:19], v[48:51]
    v_cvt_pk_bf16_f32 v80, v216, v217
    v_cvt_pk_bf16_f32 v81, v218, v219
    v_mfma_f32_16x16x32_bf16 v[52:55], a[108:111], a[20:23], v[52:55]
    v_cvt_pk_bf16_f32 v82, v228, v229
    v_cvt_pk_bf16_f32 v83, v230, v231
    v_mfma_f32_16x16x32_bf16 v[32:35], a[112:115], a[24:27], v[32:35]
    s_add_u32 m0, s38, 76032
    ds_read_b64_tr_b16 a[182:183], v7 offset:42400
    v_mfma_f32_16x16x32_bf16 v[36:39], a[112:115], a[28:31], v[36:39]
    buffer_load_dwordx4 v3, s[12:15], s33 offen nt lds
    v_mfma_f32_16x16x32_bf16 v[40:43], a[112:115], a[32:35], v[40:43]
    ds_write_b128 v9, v[80:83] offset:0
    v_mfma_f32_16x16x32_bf16 v[44:47], a[116:119], a[24:27], v[44:47]
    ds_read_b64_tr_b16 a[184:185], v7 offset:33984
    ds_read_b64_tr_b16 a[186:187], v7 offset:42432
    v_mfma_f32_16x16x32_bf16 v[48:51], a[116:119], a[28:31], v[48:51]
    v_exp_f32 v234, v74
    v_mfma_f32_16x16x32_bf16 v[52:55], a[116:119], a[32:35], v[52:55]
    v_exp_f32 v235, v75
    v_mfma_f32_16x16x32_bf16 v[32:35], a[120:123], a[36:39], v[32:35]
    s_add_u32 m0, s38, 78208
    ds_read_b64_tr_b16 a[188:189], v7 offset:34016
    v_mfma_f32_16x16x32_bf16 v[36:39], a[120:123], a[40:43], v[36:39]
    buffer_load_dwordx4 v3, s[12:15], s33 offen offset:2048 nt lds
    v_mfma_f32_16x16x32_bf16 v[40:43], a[120:123], a[44:47], v[40:43]
    v_exp_f32 v224, v64
    v_mfma_f32_16x16x32_bf16 v[44:47], a[124:127], a[36:39], v[44:47]
    ds_read_b64_tr_b16 a[190:191], v7 offset:42464
    v_cvt_pk_bf16_f32 v84, v220, v221
    v_mfma_f32_16x16x32_bf16 v[48:51], a[124:127], a[40:43], v[48:51]
    ds_read_b64_tr_b16 a[192:193], v8 offset:33792
    v_cvt_pk_bf16_f32 v85, v222, v223
    v_mfma_f32_16x16x32_bf16 v[52:55], a[124:127], a[44:47], v[52:55]
    ds_read_b64_tr_b16 a[194:195], v8 offset:42240
    v_cvt_pk_bf16_f32 v86, v232, v233
    v_mfma_f32_16x16x32_bf16 v[32:35], a[128:131], a[48:51], v[32:35]
    s_add_u32 m0, s38, 84480
    v_cvt_pk_bf16_f32 v87, v234, v235
    v_mfma_f32_16x16x32_bf16 v[36:39], a[128:131], a[52:55], v[36:39]
    buffer_load_dwordx4 v4, s[12:15], s33 offen nt lds
    v_mfma_f32_16x16x32_bf16 v[40:43], a[128:131], a[56:59], v[40:43]
    ds_read_b64_tr_b16 a[196:197], v8 offset:33824
    ds_read_b64_tr_b16 a[198:199], v8 offset:42272
    v_mfma_f32_16x16x32_bf16 v[44:47], a[132:135], a[48:51], v[44:47]
    ds_write_b128 v9, v[84:87] offset:1024
    v_mfma_f32_16x16x32_bf16 v[48:51], a[132:135], a[52:55], v[48:51]
    ds_read_b64_tr_b16 a[200:201], v8 offset:33856
    ds_read_b64_tr_b16 a[202:203], v8 offset:42304
    v_mfma_f32_16x16x32_bf16 v[52:55], a[132:135], a[56:59], v[52:55]
    s_add_u32 m0, s38, 86656
    ds_read_b64_tr_b16 a[204:205], v8 offset:33888
    v_mfma_f32_16x16x32_bf16 v[32:35], a[136:139], a[60:63], v[32:35]
    buffer_load_dwordx4 v4, s[12:15], s33 offen offset:2048 nt lds
    v_mfma_f32_16x16x32_bf16 v[36:39], a[136:139], a[64:67], v[36:39]
    v_exp_f32 v225, v65
    v_mfma_f32_16x16x32_bf16 v[40:43], a[136:139], a[68:71], v[40:43]
    v_exp_f32 v226, v66
    v_mfma_f32_16x16x32_bf16 v[44:47], a[140:143], a[60:63], v[44:47]
    v_exp_f32 v227, v67
    v_mfma_f32_16x16x32_bf16 v[48:51], a[140:143], a[64:67], v[48:51]
    ds_read_b64_tr_b16 a[206:207], v8 offset:42336
    ds_read_b64_tr_b16 a[208:209], v8 offset:33920
    v_mfma_f32_16x16x32_bf16 v[52:55], a[140:143], a[68:71], v[52:55]
    s_add_u32 m0, s38, 92928
    ds_read_b64_tr_b16 a[210:211], v8 offset:42368
    v_mfma_f32_16x16x32_bf16 v[32:35], a[144:147], a[72:75], v[32:35]
    v_exp_f32 v236, v76
    buffer_load_dwordx4 v5, s[12:15], s33 offen nt lds
    v_mfma_f32_16x16x32_bf16 v[36:39], a[144:147], a[76:79], v[36:39]
    v_exp_f32 v237, v77
    v_mfma_f32_16x16x32_bf16 v[40:43], a[144:147], a[80:83], v[40:43]
    ds_read_b64_tr_b16 a[212:213], v8 offset:33952
    ds_read_b64_tr_b16 a[214:215], v8 offset:42400
    v_mfma_f32_16x16x32_bf16 v[44:47], a[148:151], a[72:75], v[44:47]
    v_exp_f32 v238, v78
    v_mfma_f32_16x16x32_bf16 v[48:51], a[148:151], a[76:79], v[48:51]
    v_exp_f32 v239, v79
    v_mfma_f32_16x16x32_bf16 v[52:55], a[148:151], a[80:83], v[52:55]
    ds_read_b64_tr_b16 a[216:217], v8 offset:33984
    ds_read_b64_tr_b16 a[218:219], v8 offset:42432
    ds_read_b64_tr_b16 a[220:221], v8 offset:34016
    ds_read_b64_tr_b16 a[222:223], v8 offset:42464
    s_add_u32 m0, s38, 95104
    v_mfma_f32_16x16x32_bf16 v[32:35], a[152:155], a[84:87], v[32:35]
    v_cvt_pk_bf16_f32 v88, v224, v225
    buffer_load_dwordx4 v5, s[12:15], s33 offen offset:2048 nt lds
    v_mfma_f32_16x16x32_bf16 v[36:39], a[152:155], a[88:91], v[36:39]
    v_cvt_pk_bf16_f32 v89, v226, v227
    v_cvt_pk_bf16_f32 v90, v236, v237
    v_cvt_pk_bf16_f32 v91, v238, v239
    ds_write_b128 v9, v[88:91] offset:2048
    v_mfma_f32_16x16x32_bf16 v[40:43], a[152:155], a[92:95], v[40:43]
    v_mfma_f32_16x16x32_bf16 v[44:47], a[156:159], a[84:87], v[44:47]
    v_mfma_f32_16x16x32_bf16 v[48:51], a[156:159], a[88:91], v[48:51]
    s_add_u32 s33, s33, 32768
    v_mfma_f32_16x16x32_bf16 v[52:55], a[156:159], a[92:95], v[52:55]
    s_waitcnt vmcnt(8) lgkmcnt(0)
    s_barrier
    v_mfma_f32_16x16x32_bf16 v[120:123], a[160:163], v[80:83], v[120:123]
    ds_read_b128 v[92:95], v10 offset:0
    ds_read_b128 v[96:99], v10 offset:1024
    v_mfma_f32_16x16x32_bf16 v[124:127], a[160:163], v[84:87], v[124:127]
    s_add_u32 m0, s38, 101376
    ds_read_b128 v[100:103], v10 offset:2048
    v_mfma_f32_16x16x32_bf16 v[128:131], a[160:163], v[88:91], v[128:131]
    buffer_load_dwordx4 v2, s[12:15], s33 offen nt lds
    v_mfma_f32_16x16x32_bf16 v[132:135], a[164:167], v[80:83], v[132:135]
    v_fma_f32 v56, v32, s36, -v16
    v_fma_f32 v57, v33, s36, -v16
    v_mfma_f32_16x16x32_bf16 v[136:139], a[164:167], v[84:87], v[136:139]
    ds_read_b128 a[96:99], v6 offset:33792
    v_fma_f32 v58, v34, s36, -v16
    v_mfma_f32_16x16x32_bf16 v[140:143], a[164:167], v[88:91], v[140:143]
    v_fma_f32 v59, v35, s36, -v16
    v_fma_f32 v68, v44, s36, -v16
    v_mfma_f32_16x16x32_bf16 v[144:147], a[168:171], v[80:83], v[144:147]
    ds_read_b128 a[100:103], v6 offset:42240
    v_fma_f32 v69, v45, s36, -v16
    v_mfma_f32_16x16x32_bf16 v[148:151], a[168:171], v[84:87], v[148:151]
    s_add_u32 m0, s38, 103552
    v_fma_f32 v70, v46, s36, -v16
    v_mfma_f32_16x16x32_bf16 v[152:155], a[168:171], v[88:91], v[152:155]
    buffer_load_dwordx4 v2, s[12:15], s33 offen offset:2048 nt lds
    v_mfma_f32_16x16x32_bf16 v[156:159], a[172:175], v[80:83], v[156:159]
    v_fma_f32 v71, v47, s36, -v16
    v_fma_f32 v60, v36, s36, -v17
    v_mfma_f32_16x16x32_bf16 v[160:163], a[172:175], v[84:87], v[160:163]
    ds_read_b128 a[104:107], v6 offset:33856
    v_max3_f32 v19, v56, v57, v58
    v_mfma_f32_16x16x32_bf16 v[164:167], a[172:175], v[88:91], v[164:167]
    v_max3_f32 v19, v19, v59, v68
    v_max3_f32 v19, v19, v69, v70
    v_mfma_f32_16x16x32_bf16 v[168:171], a[176:179], v[80:83], v[168:171]
    ds_read_b128 a[108:111], v6 offset:42304
    v_max3_f32 v19, v19, v71, v60
    v_mfma_f32_16x16x32_bf16 v[172:175], a[176:179], v[84:87], v[172:175]
    v_fma_f32 v61, v37, s36, -v17
    v_fma_f32 v62, v38, s36, -v17
    v_mfma_f32_16x16x32_bf16 v[176:179], a[176:179], v[88:91], v[176:179]
    s_add_u32 m0, s38, 109824
    v_fma_f32 v63, v39, s36, -v17
    v_mfma_f32_16x16x32_bf16 v[180:183], a[180:183], v[80:83], v[180:183]
    buffer_load_dwordx4 v3, s[12:15], s33 offen nt lds
    v_mfma_f32_16x16x32_bf16 v[184:187], a[180:183], v[84:87], v[184:187]
    ds_read_b128 a[112:115], v6 offset:33920
    v_fma_f32 v72, v48, s36, -v17
    v_mfma_f32_16x16x32_bf16 v[188:191], a[180:183], v[88:91], v[188:191]
    v_fma_f32 v73, v49, s36, -v17
    v_fma_f32 v74, v50, s36, -v17
    v_mfma_f32_16x16x32_bf16 v[192:195], a[184:187], v[80:83], v[192:195]
    v_fma_f32 v75, v51, s36, -v17
    ds_read_b128 a[116:119], v6 offset:42368
    v_mfma_f32_16x16x32_bf16 v[196:199], a[184:187], v[84:87], v[196:199]
    v_fma_f32 v64, v40, s36, -v18
    v_max3_f32 v19, v19, v61, v62
    v_mfma_f32_16x16x32_bf16 v[200:203], a[184:187], v[88:91], v[200:203]
    s_add_u32 m0, s38, 112000
    v_max3_f32 v19, v19, v63, v72
    v_mfma_f32_16x16x32_bf16 v[204:207], a[188:191], v[80:83], v[204:207]
    buffer_load_dwordx4 v3, s[12:15], s33 offen offset:2048 nt lds
    v_mfma_f32_16x16x32_bf16 v[208:211], a[188:191], v[84:87], v[208:211]
    ds_read_b128 a[120:123], v6 offset:33984
    v_max3_f32 v19, v19, v73, v74
    v_mfma_f32_16x16x32_bf16 v[212:215], a[188:191], v[88:91], v[212:215]
    v_max3_f32 v19, v19, v75, v64
    v_fma_f32 v65, v41, s36, -v18
    v_mfma_f32_16x16x32_bf16 v[104:107], v[116:119], v[80:83], v[104:107]
    v_fma_f32 v66, v42, s36, -v18
    ds_read_b128 a[124:127], v6 offset:42432
    v_mfma_f32_16x16x32_bf16 v[108:111], v[116:119], v[84:87], v[108:111]
    v_fma_f32 v67, v43, s36, -v18
    v_fma_f32 v76, v52, s36, -v18
    v_mfma_f32_16x16x32_bf16 v[112:115], v[116:119], v[88:91], v[112:115]
    v_fma_f32 v77, v53, s36, -v18
    ds_read_b128 a[128:131], v6 offset:34048
    s_waitcnt lgkmcnt(11)
    v_mfma_f32_16x16x32_bf16 v[120:123], a[192:195], v[92:95], v[120:123]
    s_add_u32 m0, s38, 118272
    v_fma_f32 v78, v54, s36, -v18
    s_waitcnt lgkmcnt(10)
    v_mfma_f32_16x16x32_bf16 v[124:127], a[192:195], v[96:99], v[124:127]
    buffer_load_dwordx4 v4, s[12:15], s33 offen nt lds
    s_waitcnt lgkmcnt(9)
    v_mfma_f32_16x16x32_bf16 v[128:131], a[192:195], v[100:103], v[128:131]
    v_fma_f32 v79, v55, s36, -v18
    v_max3_f32 v19, v19, v65, v66
    v_mfma_f32_16x16x32_bf16 v[132:135], a[196:199], v[92:95], v[132:135]
    v_max3_f32 v19, v19, v67, v76
    ds_read_b128 a[132:135], v6 offset:42496
    v_mfma_f32_16x16x32_bf16 v[136:139], a[196:199], v[96:99], v[136:139]
    v_max3_f32 v19, v19, v77, v78
    v_max_f32 v19, v19, v79
    v_mfma_f32_16x16x32_bf16 v[140:143], a[196:199], v[100:103], v[140:143]
    v_cmp_lt_f32 vcc, s37, v19
    ds_read_b128 a[136:139], v6 offset:34112
    v_mfma_f32_16x16x32_bf16 v[144:147], a[200:203], v[92:95], v[144:147]
    s_add_u32 m0, s38, 120448
    ds_read_b128 a[140:143], v6 offset:42560
    v_mfma_f32_16x16x32_bf16 v[148:151], a[200:203], v[96:99], v[148:151]
    buffer_load_dwordx4 v4, s[12:15], s33 offen offset:2048 nt lds
    v_mfma_f32_16x16x32_bf16 v[152:155], a[200:203], v[100:103], v[152:155]
    v_exp_f32 v216, v56
    v_mfma_f32_16x16x32_bf16 v[156:159], a[204:207], v[92:95], v[156:159]
    v_exp_f32 v217, v57
    v_mfma_f32_16x16x32_bf16 v[160:163], a[204:207], v[96:99], v[160:163]
    v_exp_f32 v218, v58
    v_mfma_f32_16x16x32_bf16 v[164:167], a[204:207], v[100:103], v[164:167]
    v_exp_f32 v219, v59
    v_mfma_f32_16x16x32_bf16 v[168:171], a[208:211], v[92:95], v[168:171]
    ds_read_b128 a[144:147], v6 offset:34176
    ds_read_b128 a[148:151], v6 offset:42624
    v_mfma_f32_16x16x32_bf16 v[172:175], a[208:211], v[96:99], v[172:175]
    s_add_u32 m0, s38, 126720
    ds_read_b128 a[152:155], v6 offset:34240
    v_mfma_f32_16x16x32_bf16 v[176:179], a[208:211], v[100:103], v[176:179]
    v_exp_f32 v228, v68
    buffer_load_dwordx4 v5, s[12:15], s33 offen nt lds
    v_mfma_f32_16x16x32_bf16 v[180:183], a[212:215], v[92:95], v[180:183]
    v_exp_f32 v229, v69
    v_mfma_f32_16x16x32_bf16 v[184:187], a[212:215], v[96:99], v[184:187]
    v_exp_f32 v230, v70
    v_mfma_f32_16x16x32_bf16 v[188:191], a[212:215], v[100:103], v[188:191]
    v_exp_f32 v231, v71
    v_mfma_f32_16x16x32_bf16 v[192:195], a[216:219], v[92:95], v[192:195]
    v_exp_f32 v220, v60
    v_mfma_f32_16x16x32_bf16 v[196:199], a[216:219], v[96:99], v[196:199]
    ds_read_b128 a[156:159], v6 offset:42688
    s_add_u32 m0, s38, 128896
    v_mfma_f32_16x16x32_bf16 v[200:203], a[216:219], v[100:103], v[200:203]
    buffer_load_dwordx4 v5, s[12:15], s33 offen offset:2048 nt lds
    v_mfma_f32_16x16x32_bf16 v[204:207], a[220:223], v[92:95], v[204:207]
    v_exp_f32 v221, v61
    v_mfma_f32_16x16x32_bf16 v[208:211], a[220:223], v[96:99], v[208:211]
    v_exp_f32 v222, v62
    v_mfma_f32_16x16x32_bf16 v[212:215], a[220:223], v[100:103], v[212:215]
    v_exp_f32 v223, v63
    v_mfma_f32_16x16x32_bf16 v[104:107], v[116:119], v[92:95], v[104:107]
    v_exp_f32 v232, v72
    v_mfma_f32_16x16x32_bf16 v[108:111], v[116:119], v[96:99], v[108:111]
    v_exp_f32 v233, v73
    s_cbranch_vccnz L_sf3
L_sb3:
    s_add_u32 s33, s33, 32768
    v_mfma_f32_16x16x32_bf16 v[112:115], v[116:119], v[100:103], v[112:115]
    s_waitcnt vmcnt(8) lgkmcnt(0)
    s_barrier
    ds_read_b32 v20, v14
    v_mfma_f32_16x16x32_bf16 v[32:35], a[96:99], a[0:3], 0
    ds_read_b64_tr_b16 a[160:161], v7 offset:0
    ds_read_b64_tr_b16 a[162:163], v7 offset:8448
    v_mfma_f32_16x16x32_bf16 v[36:39], a[96:99], a[4:7], 0
    s_lshl_b32 s3, s29, 4
    ds_read_b64_tr_b16 a[164:165], v7 offset:32
    v_mfma_f32_16x16x32_bf16 v[40:43], a[96:99], a[8:11], 0
    buffer_load_dword v245, v244, s[88:91], s3 offen
    ds_read_b64_tr_b16 a[166:167], v7 offset:8480
    v_mfma_f32_16x16x32_bf16 v[44:47], a[100:103], a[0:3], 0
    ds_read_b64_tr_b16 a[168:169], v7 offset:64
    ds_read_b64_tr_b16 a[170:171], v7 offset:8512
    v_mfma_f32_16x16x32_bf16 v[48:51], a[100:103], a[4:7], 0
    ds_read_b64_tr_b16 a[172:173], v7 offset:96
    ds_read_b64_tr_b16 a[174:175], v7 offset:8544
    v_mfma_f32_16x16x32_bf16 v[52:55], a[100:103], a[8:11], 0
    v_mul_u32_u24 v31, 21568, v243
    s_mul_i32 s3, s29, 1380352
    s_add_u32 s3, s3, 86016
    v_mfma_f32_16x16x32_bf16 v[32:35], a[104:107], a[12:15], v[32:35]
    buffer_load_dword v31, v31, s[24:27], s3 offen
    ds_read_b64_tr_b16 a[176:177], v7 offset:128
    v_mfma_f32_16x16x32_bf16 v[36:39], a[104:107], a[16:19], v[36:39]
    s_waitcnt lgkmcnt(9)
    v_readfirstlane_b32 s45, v20
    ds_read_b64_tr_b16 a[178:179], v7 offset:8576
    v_mfma_f32_16x16x32_bf16 v[40:43], a[104:107], a[20:23], v[40:43]
    ds_read_b64_tr_b16 a[180:181], v7 offset:160
    v_mfma_f32_16x16x32_bf16 v[44:47], a[108:111], a[12:15], v[44:47]
    s_cmp_eq_u32 s45, 0
    s_cbranch_scc0 L_call3
L_back3:
    s_mul_i32 s3, s29, 86016
    v_mfma_f32_16x16x32_bf16 v[48:51], a[108:111], a[16:19], v[48:51]
    buffer_load_dword v2, v244, s[84:87], s3 offen
    v_cvt_pk_bf16_f32 v80, v216, v217
    v_mfma_f32_16x16x32_bf16 v[52:55], a[108:111], a[20:23], v[52:55]
    v_add_u32 v24, 0, v13
    v_cvt_pk_bf16_f32 v81, v218, v219
    v_mfma_f32_16x16x32_bf16 v[32:35], a[112:115], a[24:27], v[32:35]
    v_cvt_pk_bf16_f32 v82, v228, v229
    v_cvt_pk_bf16_f32 v83, v230, v231
    v_mfma_f32_16x16x32_bf16 v[36:39], a[112:115], a[28:31], v[36:39]
    s_lshl_b32 s42, s47, 7
    s_add_u32 s42, s42, s56
    s_add_u32 m0, s53, 0
    s_add_u32 s47, s47, 1
    s_cmp_eq_u32 s47, 7
    s_cselect_b32 s47, 0, s47
    v_mfma_f32_16x16x32_bf16 v[40:43], a[112:115], a[32:35], v[40:43]
    buffer_load_dwordx4 v12, s[20:23], s42 offen  lds
    v_add_u32 v25, 33792, v13
    v_mfma_f32_16x16x32_bf16 v[44:47], a[116:119], a[24:27], v[44:47]
    ds_write_b128 v9, v[80:83] offset:0
    v_mfma_f32_16x16x32_bf16 v[48:51], a[116:119], a[28:31], v[48:51]
    ds_read_b64_tr_b16 a[182:183], v7 offset:8608
    v_add_u32 v26, 67584, v13
    v_mfma_f32_16x16x32_bf16 v[52:55], a[116:119], a[32:35], v[52:55]
    s_add_u32 m0, s53, 4096
    s_add_u32 s42, s42, 28672
    ds_read_b64_tr_b16 a[184:185], v7 offset:192
    v_mfma_f32_16x16x32_bf16 v[32:35], a[120:123], a[36:39], v[32:35]
    buffer_load_dwordx4 v12, s[20:23], s42 offen  lds
    ds_read_b64_tr_b16 a[186:187], v7 offset:8640
    v_mfma_f32_16x16x32_bf16 v[36:39], a[120:123], a[40:43], v[36:39]
    v_exp_f32 v234, v74
    v_mfma_f32_16x16x32_bf16 v[40:43], a[120:123], a[44:47], v[40:43]
    v_exp_f32 v235, v75
    v_mfma_f32_16x16x32_bf16 v[44:47], a[124:127], a[36:39], v[44:47]
    s_add_u32 m0, s53, 8192
    s_add_u32 s42, s42, 28672
    ds_read_b64_tr_b16 a[188:189], v7 offset:224
    v_mfma_f32_16x16x32_bf16 v[48:51], a[124:127], a[40:43], v[48:51]
    buffer_load_dwordx4 v12, s[20:23], s42 offen  lds
    v_add_u32 v27, 101376, v13
    v_mfma_f32_16x16x32_bf16 v[52:55], a[124:127], a[44:47], v[52:55]
    v_exp_f32 v224, v64
    v_mfma_f32_16x16x32_bf16 v[32:35], a[128:131], a[48:51], v[32:35]
    ds_read_b64_tr_b16 a[190:191], v7 offset:8672
    v_cvt_pk_bf16_f32 v84, v220, v221
    v_mfma_f32_16x16x32_bf16 v[36:39], a[128:131], a[52:55], v[36:39]
    ds_read_b64_tr_b16 a[192:193], v8 offset:0
    v_cvt_pk_bf16_f32 v85, v222, v223
    ds_read_b64_tr_b16 a[194:195], v8 offset:8448
    v_mfma_f32_16x16x32_bf16 v[40:43], a[128:131], a[56:59], v[40:43]
    s_cmp_eq_u32 s28, 3
    s_cselect_b32 s35, 0, 0x40000000
    s_add_u32 m0, s53, 12288
    s_add_u32 s42, s42, 28672
    v_mfma_f32_16x16x32_bf16 v[44:47], a[132:135], a[48:51], v[44:47]
    v_cvt_pk_bf16_f32 v86, v232, v233
    buffer_load_dwordx4 v12, s[20:23], s42 offen  lds
    v_mfma_f32_16x16x32_bf16 v[48:51], a[132:135], a[52:55], v[48:51]
    v_cvt_pk_bf16_f32 v87, v234, v235
    ds_read_b64_tr_b16 a[196:197], v8 offset:32
    ds_write_b128 v9, v[84:87] offset:1024
    v_mfma_f32_16x16x32_bf16 v[52:55], a[132:135], a[56:59], v[52:55]
    ds_read_b64_tr_b16 a[198:199], v8 offset:8480
    ds_read_b64_tr_b16 a[200:201], v8 offset:64
    s_lshl_b32 s43, s30, 2
    v_mfma_f32_16x16x32_bf16 v[32:35], a[136:139], a[60:63], v[32:35]
    s_add_u32 m0, s53, 16384
    s_add_u32 s42, s42, 28672
    ds_read_b64_tr_b16 a[202:203], v8 offset:8512
    v_mfma_f32_16x16x32_bf16 v[36:39], a[136:139], a[64:67], v[36:39]
    buffer_load_dwordx4 v12, s[20:23], s42 offen  lds
    ds_read_b64_tr_b16 a[204:205], v8 offset:96
    v_mfma_f32_16x16x32_bf16 v[40:43], a[136:139], a[68:71], v[40:43]
    v_exp_f32 v225, v65
    s_add_u32 s35, s35, s43
    v_mfma_f32_16x16x32_bf16 v[44:47], a[140:143], a[60:63], v[44:47]
    v_exp_f32 v226, v66
    s_add_u32 s35, s35, s34
    v_mfma_f32_16x16x32_bf16 v[48:51], a[140:143], a[64:67], v[48:51]
    s_add_u32 m0, s53, 20480
    s_add_u32 s42, s42, 28672
    ds_read_b64_tr_b16 a[206:207], v8 offset:8544
    v_mfma_f32_16x16x32_bf16 v[52:55], a[140:143], a[68:71], v[52:55]
    v_exp_f32 v227, v67
    buffer_load_dwordx4 v12, s[20:23], s42 offen  lds
    v_mfma_f32_16x16x32_bf16 v[32:35], a[144:147], a[72:75], v[32:35]
    ds_read_b64_tr_b16 a[208:209], v8 offset:128
    v_exp_f32 v236, v76
    v_mfma_f32_16x16x32_bf16 v[36:39], a[144:147], a[76:79], v[36:39]
    ds_read_b64_tr_b16 a[210:211], v8 offset:8576
    ds_read_b64_tr_b16 a[212:213], v8 offset:160
    v_mfma_f32_16x16x32_bf16 v[40:43], a[144:147], a[80:83], v[40:43]
    v_exp_f32 v237, v77
    s_add_u32 m0, s53, 24576
    s_add_u32 s42, s42, 28672
    v_mfma_f32_16x16x32_bf16 v[44:47], a[148:151], a[72:75], v[44:47]
    v_mov_b32 v252, 1
    v_exp_f32 v238, v78
    v_mov_b32 v253, 2
    buffer_load_dwordx4 v12, s[20:23], s42 offen  lds
    v_mfma_f32_16x16x32_bf16 v[48:51], a[148:151], a[76:79], v[48:51]
    ds_read_b64_tr_b16 a[214:215], v8 offset:8608
    ds_read_b64_tr_b16 a[216:217], v8 offset:192
    v_mfma_f32_16x16x32_bf16 v[52:55], a[148:151], a[80:83], v[52:55]
    v_exp_f32 v239, v79
    ds_read_b64_tr_b16 a[218:219], v8 offset:8640
    ds_read_b64_tr_b16 a[220:221], v8 offset:224
    ds_read_b64_tr_b16 a[222:223], v8 offset:8672
    v_mfma_f32_16x16x32_bf16 v[32:35], a[152:155], a[84:87], v[32:35]
    v_cvt_pk_bf16_f32 v88, v224, v225
    s_add_u32 m0, s53, 28672
    s_add_u32 s42, s42, 28672
    v_mfma_f32_16x16x32_bf16 v[36:39], a[152:155], a[88:91], v[36:39]
    v_cvt_pk_bf16_f32 v89, v226, v227
    v_cvt_pk_bf16_f32 v90, v236, v237
    v_cvt_pk_bf16_f32 v91, v238, v239
    ds_write_b128 v9, v[88:91] offset:2048
    buffer_load_dwordx4 v12, s[20:23], s42 offen  lds
    v_mfma_f32_16x16x32_bf16 v[40:43], a[152:155], a[92:95], v[40:43]
    v_mfma_f32_16x16x32_bf16 v[44:47], a[156:159], a[84:87], v[44:47]
    v_mfma_f32_16x16x32_bf16 v[48:51], a[156:159], a[88:91], v[48:51]
    v_mfma_f32_16x16x32_bf16 v[52:55], a[156:159], a[92:95], v[52:55]
    s_waitcnt lgkmcnt(0)
    s_barrier
    v_mfma_f32_16x16x32_bf16 v[120:123], a[160:163], v[80:83], v[120:123]
    ds_read_b128 v[92:95], v10 offset:0
    ds_read_b128 v[96:99], v10 offset:1024
    ds_read_b128 v[100:103], v10 offset:2048
    v_mfma_f32_16x16x32_bf16 v[124:127], a[160:163], v[84:87], v[124:127]
    s_lshl_b32 s42, s47, 7
    s_add_u32 s42, s42, s56
    s_add_u32 m0, s53, 33792
    s_add_u32 s47, s47, 1
    s_cmp_eq_u32 s47, 7
    s_cselect_b32 s47, 0, s47
    v_mfma_f32_16x16x32_bf16 v[128:131], a[160:163], v[88:91], v[128:131]
    buffer_load_dwordx4 v12, s[20:23], s42 offen  lds
    v_fma_f32 v56, v32, s36, -v16
    v_mfma_f32_16x16x32_bf16 v[132:135], a[164:167], v[80:83], v[132:135]
    v_fma_f32 v57, v33, s36, -v16
    v_fma_f32 v58, v34, s36, -v16
    v_fma_f32 v59, v35, s36, -v16
    v_mfma_f32_16x16x32_bf16 v[136:139], a[164:167], v[84:87], v[136:139]
    v_fma_f32 v68, v44, s36, -v16
    v_fma_f32 v69, v45, s36, -v16
    v_fma_f32 v70, v46, s36, -v16
    v_mfma_f32_16x16x32_bf16 v[140:143], a[164:167], v[88:91], v[140:143]
    s_add_u32 m0, s53, 37888
    s_add_u32 s42, s42, 28672
    v_fma_f32 v71, v47, s36, -v16
    v_mfma_f32_16x16x32_bf16 v[144:147], a[168:171], v[80:83], v[144:147]
    buffer_load_dwordx4 v12, s[20:23], s42 offen  lds
    v_fma_f32 v60, v36, s36, -v17
    v_mfma_f32_16x16x32_bf16 v[148:151], a[168:171], v[84:87], v[148:151]
    v_max3_f32 v19, v56, v57, v58
    v_max3_f32 v19, v19, v59, v68
    v_max3_f32 v19, v19, v69, v70
    v_mfma_f32_16x16x32_bf16 v[152:155], a[168:171], v[88:91], v[152:155]
    v_max3_f32 v19, v19, v71, v60
    v_fma_f32 v61, v37, s36, -v17
    v_fma_f32 v62, v38, s36, -v17
    v_mfma_f32_16x16x32_bf16 v[156:159], a[172:175], v[80:83], v[156:159]
    v_fma_f32 v63, v39, s36, -v17
    v_fma_f32 v72, v48, s36, -v17
    v_fma_f32 v73, v49, s36, -v17
    v_mfma_f32_16x16x32_bf16 v[160:163], a[172:175], v[84:87], v[160:163]
    s_add_u32 m0, s53, 41984
    s_add_u32 s42, s42, 28672
    v_fma_f32 v74, v50, s36, -v17
    v_mfma_f32_16x16x32_bf16 v[164:167], a[172:175], v[88:91], v[164:167]
    buffer_load_dwordx4 v12, s[20:23], s42 offen  lds
    v_mfma_f32_16x16x32_bf16 v[168:171], a[176:179], v[80:83], v[168:171]
    v_fma_f32 v75, v51, s36, -v17
    v_fma_f32 v64, v40, s36, -v18
    v_max3_f32 v19, v19, v61, v62
    v_mfma_f32_16x16x32_bf16 v[172:175], a[176:179], v[84:87], v[172:175]
    v_max3_f32 v19, v19, v63, v72
    v_max3_f32 v19, v19, v73, v74
    v_max3_f32 v19, v19, v75, v64
    v_mfma_f32_16x16x32_bf16 v[176:179], a[176:179], v[88:91], v[176:179]
    v_fma_f32 v65, v41, s36, -v18
    v_fma_f32 v66, v42, s36, -v18
    v_fma_f32 v67, v43, s36, -v18
    v_mfma_f32_16x16x32_bf16 v[180:183], a[180:183], v[80:83], v[180:183]
    s_add_u32 m0, s53, 46080
    s_add_u32 s42, s42, 28672
    v_fma_f32 v76, v52, s36, -v18
    v_mfma_f32_16x16x32_bf16 v[184:187], a[180:183], v[84:87], v[184:187]
    buffer_load_dwordx4 v12, s[20:23], s42 offen  lds
    v_fma_f32 v77, v53, s36, -v18
    v_mfma_f32_16x16x32_bf16 v[188:191], a[180:183], v[88:91], v[188:191]
    v_fma_f32 v78, v54, s36, -v18
    v_fma_f32 v79, v55, s36, -v18
    v_max3_f32 v19, v19, v65, v66
    v_mfma_f32_16x16x32_bf16 v[192:195], a[184:187], v[80:83], v[192:195]
    v_max3_f32 v19, v19, v67, v76
    v_max3_f32 v19, v19, v77, v78
    v_max_f32 v19, v19, v79
    v_mfma_f32_16x16x32_bf16 v[196:199], a[184:187], v[84:87], v[196:199]
    v_cmp_lt_f32 vcc, s37, v19
    v_exp_f32 v216, v56
    v_mfma_f32_16x16x32_bf16 v[200:203], a[184:187], v[88:91], v[200:203]
    s_add_u32 m0, s53, 50176
    s_add_u32 s42, s42, 28672
    v_mfma_f32_16x16x32_bf16 v[204:207], a[188:191], v[80:83], v[204:207]
    v_exp_f32 v217, v57
    v_exp_f32 v218, v58
    buffer_load_dwordx4 v12, s[20:23], s42 offen  lds
    s_cbranch_vccnz L_sf4
L_sb4:
    v_mfma_f32_16x16x32_bf16 v[208:211], a[188:191], v[84:87], v[208:211]
    v_mfma_f32_16x16x32_bf16 v[212:215], a[188:191], v[88:91], v[212:215]
    s_waitcnt vmcnt(16) lgkmcnt(0)
    s_barrier
    ds_read_b32 v20, v14
    v_mfma_f32_16x16x32_bf16 v[104:107], v[116:119], v[80:83], v[104:107]
    v_exp_f32 v219, v59
    ds_read_b64_tr_b16 a[96:97], v7 offset:33792
    v_mfma_f32_16x16x32_bf16 v[108:111], v[116:119], v[84:87], v[108:111]
    s_add_u32 m0, s53, 54272
    s_add_u32 s42, s42, 28672
    ds_read_b64_tr_b16 a[98:99], v7 offset:42240
    v_mfma_f32_16x16x32_bf16 v[112:115], v[116:119], v[88:91], v[112:115]
    buffer_load_dwordx4 v12, s[20:23], s42 offen  lds
    ds_read_b64_tr_b16 a[100:101], v7 offset:33824
    v_mfma_f32_16x16x32_bf16 v[120:123], a[192:195], v[92:95], v[120:123]
    v_exp_f32 v228, v68
    v_exp_f32 v229, v69
    v_exp_f32 v230, v70
    v_exp_f32 v231, v71
    v_exp_f32 v220, v60
    v_mfma_f32_16x16x32_bf16 v[124:127], a[192:195], v[96:99], v[124:127]
    v_cvt_pk_bf16_f32 v80, v216, v217
    v_cvt_pk_bf16_f32 v81, v218, v219
    v_cvt_pk_bf16_f32 v82, v228, v229
    v_mfma_f32_16x16x32_bf16 v[128:131], a[192:195], v[100:103], v[128:131]
    ds_read_b64_tr_b16 a[102:103], v7 offset:42272
    v_cvt_pk_bf16_f32 v83, v230, v231
    ds_read_b64_tr_b16 a[128:129], v8 offset:33792
    v_mfma_f32_16x16x32_bf16 v[132:135], a[196:199], v[92:95], v[132:135]
    s_add_u32 m0, s53, 58368
    s_add_u32 s42, s42, 28672
    ds_read_b64_tr_b16 a[130:131], v8 offset:42240
    v_mfma_f32_16x16x32_bf16 v[136:139], a[196:199], v[96:99], v[136:139]
    buffer_load_dwordx4 v12, s[20:23], s42 offen  lds
    ds_read_b64_tr_b16 a[132:133], v8 offset:33824
    v_mfma_f32_16x16x32_bf16 v[140:143], a[196:199], v[100:103], v[140:143]
    ds_write_b128 v9, v[80:83] offset:12288
    v_mfma_f32_16x16x32_bf16 v[144:147], a[200:203], v[92:95], v[144:147]
    v_exp_f32 v221, v61
    ds_read_b64_tr_b16 a[134:135], v8 offset:42272
    v_mfma_f32_16x16x32_bf16 v[148:151], a[200:203], v[96:99], v[148:151]
    v_exp_f32 v222, v62
    ds_read_b64_tr_b16 a[104:105], v7 offset:33856
    v_mfma_f32_16x16x32_bf16 v[152:155], a[200:203], v[100:103], v[152:155]
    s_add_u32 m0, s53, 62464
    s_add_u32 s42, s42, 28672
    ds_read_b64_tr_b16 a[106:107], v7 offset:42304
    v_mfma_f32_16x16x32_bf16 v[156:159], a[204:207], v[92:95], v[156:159]
    buffer_load_dwordx4 v12, s[20:23], s42 offen  lds
    ds_read_b64_tr_b16 a[108:109], v7 offset:33888
    v_mfma_f32_16x16x32_bf16 v[160:163], a[204:207], v[96:99], v[160:163]
    v_exp_f32 v223, v63
    ds_read_b64_tr_b16 a[110:111], v7 offset:42336
    v_mfma_f32_16x16x32_bf16 v[164:167], a[204:207], v[100:103], v[164:167]
    v_exp_f32 v232, v72
    v_mfma_f32_16x16x32_bf16 v[168:171], a[208:211], v[92:95], v[168:171]
    v_exp_f32 v233, v73
    v_mfma_f32_16x16x32_bf16 v[172:175], a[208:211], v[96:99], v[172:175]
    v_exp_f32 v234, v74
    s_waitcnt lgkmcnt(13)
    v_readfirstlane_b32 s45, v20
    v_mfma_f32_16x16x32_bf16 v[176:179], a[208:211], v[100:103], v[176:179]
    v_exp_f32 v235, v75
    v_exp_f32 v224, v64
    v_mfma_f32_16x16x32_bf16 v[180:183], a[212:215], v[92:95], v[180:183]
    v_cvt_pk_bf16_f32 v84, v220, v221
    v_cvt_pk_bf16_f32 v85, v222, v223
    v_mfma_f32_16x16x32_bf16 v[184:187], a[212:215], v[96:99], v[184:187]
    v_cvt_pk_bf16_f32 v86, v232, v233
    v_cvt_pk_bf16_f32 v87, v234, v235
    ds_read_b64_tr_b16 a[136:137], v8 offset:33856
    v_mfma_f32_16x16x32_bf16 v[188:191], a[212:215], v[100:103], v[188:191]
    ds_write_b128 v9, v[84:87] offset:13312
    v_mfma_f32_16x16x32_bf16 v[192:195], a[216:219], v[92:95], v[192:195]
    v_exp_f32 v225, v65
    v_mfma_f32_16x16x32_bf16 v[196:199], a[216:219], v[96:99], v[196:199]
    v_exp_f32 v226, v66
    ds_read_b64_tr_b16 a[138:139], v8 offset:42304
    v_mfma_f32_16x16x32_bf16 v[200:203], a[216:219], v[100:103], v[200:203]
    v_exp_f32 v227, v67
    v_mfma_f32_16x16x32_bf16 v[204:207], a[220:223], v[92:95], v[204:207]
    v_exp_f32 v236, v76
    ds_read_b64_tr_b16 a[140:141], v8 offset:33888
    v_mfma_f32_16x16x32_bf16 v[208:211], a[220:223], v[96:99], v[208:211]
    v_exp_f32 v237, v77
    v_exp_f32 v238, v78
    v_exp_f32 v239, v79
    v_cvt_pk_bf16_f32 v88, v224, v225
    v_cvt_pk_bf16_f32 v89, v226, v227
    v_cvt_pk_bf16_f32 v90, v236, v237
    v_cvt_pk_bf16_f32 v91, v238, v239
    ds_write_b128 v9, v[88:91] offset:14336
    ds_read_b64_tr_b16 a[142:143], v8 offset:42336
    v_mfma_f32_16x16x32_bf16 v[212:215], a[220:223], v[100:103], v[212:215]
    v_mfma_f32_16x16x32_bf16 v[104:107], v[116:119], v[92:95], v[104:107]
    v_mfma_f32_16x16x32_bf16 v[108:111], v[116:119], v[96:99], v[108:111]
    v_mfma_f32_16x16x32_bf16 v[112:115], v[116:119], v[100:103], v[112:115]
    s_cmp_eq_u32 s45, 0
    s_cbranch_scc0 L_call4
L_back4:
    s_waitcnt vmcnt(8) lgkmcnt(0)
    s_barrier
    ds_read_b128 v[92:95], v10 offset:12288
    ds_read_b128 v[96:99], v10 offset:13312
    ds_read_b128 v[100:103], v10 offset:14336
    v_mfma_f32_16x16x32_bf16 v[104:107], v[116:119], v[80:83], v[104:107]
    s_lshl_b32 s42, s47, 7
    s_add_u32 s42, s42, s56
    s_add_u32 m0, s53, 67584
    s_add_u32 s47, s47, 1
    s_cmp_eq_u32 s47, 7
    s_cselect_b32 s47, 0, s47
    v_mfma_f32_16x16x32_bf16 v[108:111], v[116:119], v[84:87], v[108:111]
    buffer_load_dwordx4 v12, s[20:23], s42 offen  lds
    ds_read_b64_tr_b16 a[112:113], v7 offset:33920
    v_mfma_f32_16x16x32_bf16 v[112:115], v[116:119], v[88:91], v[112:115]
    v_readfirstlane_b32 s45, v245
    ds_read_b64_tr_b16 a[114:115], v7 offset:42368
    v_mfma_f32_16x16x32_bf16 v[120:123], a[96:99], v[80:83], v[120:123]
    ds_read_b64_tr_b16 a[116:117], v7 offset:33952
    ds_read_b64_tr_b16 a[118:119], v7 offset:42400
    v_mfma_f32_16x16x32_bf16 v[124:127], a[96:99], v[84:87], v[124:127]
    ds_read_b64_tr_b16 a[144:145], v8 offset:33920
    ds_read_b64_tr_b16 a[146:147], v8 offset:42368
    v_mfma_f32_16x16x32_bf16 v[128:131], a[96:99], v[88:91], v[128:131]
    s_cmp_eq_u32 s45, 0
    s_cbranch_scc1 L_notrdy
L_rdy:
    s_add_u32 m0, s53, 71680
    s_add_u32 s42, s42, 28672
    v_mfma_f32_16x16x32_bf16 v[132:135], a[100:103], v[80:83], v[132:135]
    buffer_load_dwordx4 v12, s[20:23], s42 offen  lds
    ds_read_b64_tr_b16 a[148:149], v8 offset:33952
    v_mfma_f32_16x16x32_bf16 v[136:139], a[100:103], v[84:87], v[136:139]
    ds_read_b64_tr_b16 a[150:151], v8 offset:42400
    ds_read_b64_tr_b16 a[120:121], v7 offset:33984
    v_mfma_f32_16x16x32_bf16 v[140:143], a[100:103], v[88:91], v[140:143]
    ds_read_b64_tr_b16 a[122:123], v7 offset:42432
    ds_read_b64_tr_b16 a[124:125], v7 offset:34016
    s_waitcnt lgkmcnt(13)
    v_mfma_f32_16x16x32_bf16 v[104:107], v[116:119], v[92:95], v[104:107]
    ds_read_b64_tr_b16 a[126:127], v7 offset:42464
    ds_read_b64_tr_b16 a[152:153], v8 offset:33984
    s_waitcnt lgkmcnt(14)
    v_mfma_f32_16x16x32_bf16 v[108:111], v[116:119], v[96:99], v[108:111]
    ds_read_b64_tr_b16 a[154:155], v8 offset:42432
    ds_read_b64_tr_b16 a[156:157], v8 offset:34016
    s_waitcnt lgkmcnt(15)
    v_mfma_f32_16x16x32_bf16 v[112:115], v[116:119], v[100:103], v[112:115]
    s_add_u32 m0, s53, 75776
    s_add_u32 s42, s42, 28672
    ds_read_b64_tr_b16 a[158:159], v8 offset:42464
    v_mfma_f32_16x16x32_bf16 v[120:123], a[128:131], v[92:95], v[120:123]
    buffer_load_dwordx4 v12, s[20:23], s42 offen  lds
    ds_read_b64_tr_b16 a[224:225], v24 offset:0
    v_mfma_f32_16x16x32_bf16 v[124:127], a[128:131], v[96:99], v[124:127]
    ds_read_b64_tr_b16 a[226:227], v24 offset:2048
    ds_read_b64_tr_b16 a[228:229], v24 offset:4096
    v_mfma_f32_16x16x32_bf16 v[128:131], a[128:131], v[100:103], v[128:131]
    ds_read_b64_tr_b16 a[230:231], v24 offset:6144
    ds_read_b64_tr_b16 a[232:233], v24 offset:8192
    v_mfma_f32_16x16x32_bf16 v[132:135], a[132:135], v[92:95], v[132:135]
    ds_read_b64_tr_b16 a[234:235], v24 offset:10240
    ds_read_b64_tr_b16 a[236:237], v24 offset:12288
    v_mfma_f32_16x16x32_bf16 v[136:139], a[132:135], v[96:99], v[136:139]
    ds_read_b64_tr_b16 a[238:239], v24 offset:14336
    ds_read_b64_tr_b16 a[240:241], v24 offset:16384
    v_mfma_f32_16x16x32_bf16 v[140:143], a[132:135], v[100:103], v[140:143]
    ds_read_b64_tr_b16 a[242:243], v24 offset:18432
    ds_read_b64_tr_b16 a[244:245], v24 offset:20480
    v_add_u32 v222, 162816, v243
    ds_read_b64_tr_b16 a[246:247], v24 offset:22528
    s_mul_i32 s3, s28, 192
    v_add_u32 v223, s3, v222
    ds_read_b64_tr_b16 a[248:249], v24 offset:24576
    ds_write_b32 v223, v104 offset:0
    ds_read_b64_tr_b16 a[250:251], v24 offset:26624
    ds_write_b32 v223, v108 offset:64
    ds_read_b64_tr_b16 a[252:253], v24 offset:28672
    s_add_u32 m0, s53, 79872
    s_add_u32 s42, s42, 28672
    ds_write_b32 v223, v112 offset:128
    ds_read_b64_tr_b16 a[254:255], v24 offset:30720
    v_mfma_f32_16x16x32_bf16 v[144:147], a[104:107], v[80:83], v[144:147]
    buffer_load_dwordx4 v12, s[20:23], s42 offen  lds
    v_mfma_f32_16x16x32_bf16 v[148:151], a[104:107], v[84:87], v[148:151]
    s_waitcnt vmcnt(4) lgkmcnt(0)
    s_barrier
    v_mfma_f32_16x16x32_bf16 v[152:155], a[104:107], v[88:91], v[152:155]
    v_cvt_pk_bf16_f32 v32, v120, v121
    v_cvt_pk_bf16_f32 v33, v122, v123
    v_mfma_f32_16x16x32_bf16 v[156:159], a[108:111], v[80:83], v[156:159]
    v_cvt_pk_bf16_f32 v34, v132, v133
    v_cvt_pk_bf16_f32 v35, v134, v135
    v_mfma_f32_16x16x32_bf16 v[160:163], a[108:111], v[84:87], v[160:163]
    ds_write_b128 v254, v[32:35] offset:0
    v_mfma_f32_16x16x32_bf16 v[164:167], a[108:111], v[88:91], v[164:167]
    s_add_u32 m0, s53, 83968
    s_add_u32 s42, s42, 28672
    v_cvt_pk_bf16_f32 v36, v124, v125
    v_mfma_f32_16x16x32_bf16 v[144:147], a[136:139], v[92:95], v[144:147]
    buffer_load_dwordx4 v12, s[20:23], s42 offen  lds
    v_cvt_pk_bf16_f32 v37, v126, v127
    v_mfma_f32_16x16x32_bf16 v[148:151], a[136:139], v[96:99], v[148:151]
    v_cvt_pk_bf16_f32 v38, v136, v137
    v_cvt_pk_bf16_f32 v39, v138, v139
    v_mfma_f32_16x16x32_bf16 v[152:155], a[136:139], v[100:103], v[152:155]
    ds_write_b128 v254, v[36:39] offset:1024
    v_mfma_f32_16x16x32_bf16 v[156:159], a[140:143], v[92:95], v[156:159]
    v_cvt_pk_bf16_f32 v40, v128, v129
    v_cvt_pk_bf16_f32 v41, v130, v131
    v_mfma_f32_16x16x32_bf16 v[160:163], a[140:143], v[96:99], v[160:163]
    s_add_u32 m0, s53, 88064
    s_add_u32 s42, s42, 28672
    v_cvt_pk_bf16_f32 v42, v140, v141
    v_mfma_f32_16x16x32_bf16 v[164:167], a[140:143], v[100:103], v[164:167]
    buffer_load_dwordx4 v12, s[20:23], s42 offen  lds
    v_cvt_pk_bf16_f32 v43, v142, v143
    v_mfma_f32_16x16x32_bf16 v[168:171], a[112:115], v[80:83], v[168:171]
    ds_write_b128 v254, v[40:43] offset:2048
    v_mfma_f32_16x16x32_bf16 v[172:175], a[112:115], v[84:87], v[172:175]
    v_mfma_f32_16x16x32_bf16 v[176:179], a[112:115], v[88:91], v[176:179]
    v_cvt_pk_bf16_f32 v44, v144, v145
    v_cvt_pk_bf16_f32 v45, v146, v147
    v_mfma_f32_16x16x32_bf16 v[180:183], a[116:119], v[80:83], v[180:183]
    v_cvt_pk_bf16_f32 v46, v156, v157
    v_cvt_pk_bf16_f32 v47, v158, v159
    v_mfma_f32_16x16x32_bf16 v[184:187], a[116:119], v[84:87], v[184:187]
    s_add_u32 m0, s53, 92160
    s_add_u32 s42, s42, 28672
    v_mfma_f32_16x16x32_bf16 v[188:191], a[116:119], v[88:91], v[188:191]
    buffer_load_dwordx4 v12, s[20:23], s42 offen  lds
    v_mfma_f32_16x16x32_bf16 v[168:171], a[144:147], v[92:95], v[168:171]
    ds_write_b128 v254, v[44:47] offset:3072
    v_mfma_f32_16x16x32_bf16 v[172:175], a[144:147], v[96:99], v[172:175]
    v_cvt_pk_bf16_f32 v48, v148, v149
    v_cvt_pk_bf16_f32 v49, v150, v151
    v_mfma_f32_16x16x32_bf16 v[176:179], a[144:147], v[100:103], v[176:179]
    v_cvt_pk_bf16_f32 v50, v160, v161
    v_cvt_pk_bf16_f32 v51, v162, v163
    v_mfma_f32_16x16x32_bf16 v[180:183], a[148:151], v[92:95], v[180:183]
    ds_write_b128 v254, v[48:51] offset:4096
    v_mfma_f32_16x16x32_bf16 v[184:187], a[148:151], v[96:99], v[184:187]
    s_add_u32 m0, s53, 96256
    s_add_u32 s42, s42, 28672
    v_cvt_pk_bf16_f32 v52, v152, v153
    v_mfma_f32_16x16x32_bf16 v[188:191], a[148:151], v[100:103], v[188:191]
    buffer_load_dwordx4 v12, s[20:23], s42 offen  lds
    v_cvt_pk_bf16_f32 v53, v154, v155
    v_mfma_f32_16x16x32_bf16 v[192:195], a[120:123], v[80:83], v[192:195]
    v_cvt_pk_bf16_f32 v54, v164, v165
    v_cvt_pk_bf16_f32 v55, v166, v167
    v_mfma_f32_16x16x32_bf16 v[196:199], a[120:123], v[84:87], v[196:199]
    ds_write_b128 v254, v[52:55] offset:5120
    v_mfma_f32_16x16x32_bf16 v[200:203], a[120:123], v[88:91], v[200:203]
    v_cvt_pk_bf16_f32 v56, v168, v169
    v_cvt_pk_bf16_f32 v57, v170, v171
    v_mfma_f32_16x16x32_bf16 v[204:207], a[124:127], v[80:83], v[204:207]
    v_cvt_pk_bf16_f32 v58, v180, v181
    v_cvt_pk_bf16_f32 v59, v182, v183
    v_mfma_f32_16x16x32_bf16 v[208:211], a[124:127], v[84:87], v[208:211]
    ds_write_b128 v9, v[56:59] offset:0
    v_mfma_f32_16x16x32_bf16 v[212:215], a[124:127], v[88:91], v[212:215]
    v_cvt_pk_bf16_f32 v60, v172, v173
    v_cvt_pk_bf16_f32 v61, v174, v175
    v_mfma_f32_16x16x32_bf16 v[192:195], a[152:155], v[92:95], v[192:195]
    v_cvt_pk_bf16_f32 v62, v184, v185
    v_cvt_pk_bf16_f32 v63, v186, v187
    v_mfma_f32_16x16x32_bf16 v[196:199], a[152:155], v[96:99], v[196:199]
    ds_write_b128 v9, v[60:63] offset:1024
    v_mfma_f32_16x16x32_bf16 v[200:203], a[152:155], v[100:103], v[200:203]
    v_cvt_pk_bf16_f32 v64, v176, v177
    v_cvt_pk_bf16_f32 v65, v178, v179
    v_mfma_f32_16x16x32_bf16 v[204:207], a[156:159], v[92:95], v[204:207]
    v_cvt_pk_bf16_f32 v66, v188, v189
    v_cvt_pk_bf16_f32 v67, v190, v191
    v_mfma_f32_16x16x32_bf16 v[208:211], a[156:159], v[96:99], v[208:211]
    ds_write_b128 v9, v[64:67] offset:2048
    v_mfma_f32_16x16x32_bf16 v[212:215], a[156:159], v[100:103], v[212:215]
    v_cvt_pk_bf16_f32 v68, v192, v193
    v_cvt_pk_bf16_f32 v69, v194, v195
    s_nop 0
    v_cvt_pk_bf16_f32 v70, v204, v205
    v_cvt_pk_bf16_f32 v71, v206, v207
    ds_write_b128 v10, v[68:71] offset:12288
    v_cvt_pk_bf16_f32 v72, v196, v197
    v_cvt_pk_bf16_f32 v73, v198, v199
    v_cvt_pk_bf16_f32 v74, v208, v209
    v_cvt_pk_bf16_f32 v75, v210, v211
    ds_write_b128 v10, v[72:75] offset:13312
    v_cvt_pk_bf16_f32 v76, v200, v201
    v_cvt_pk_bf16_f32 v77, v202, v203
    v_cvt_pk_bf16_f32 v78, v212, v213
    v_cvt_pk_bf16_f32 v79, v214, v215
    ds_write_b128 v10, v[76:79] offset:14336
    s_waitcnt lgkmcnt(0)
    s_barrier
    s_mov_b32 s48, s44
    ds_read_b32 v216, v222 offset:0
    ds_read_b32 v217, v222 offset:64
    ds_read_b32 v218, v222 offset:128
    ds_read_b32 v219, v222 offset:192
    ds_read_b32 v220, v222 offset:256
    ds_read_b32 v221, v222 offset:320
    ds_read_b128 a[0:3], v15 offset:0
    ds_read_b128 a[4:7], v15 offset:1024
    ds_read_b128 a[24:27], v15 offset:3072
    ds_read_b128 a[28:31], v15 offset:4096
    ds_read_b128 a[48:51], v15 offset:33792
    ds_read_b128 a[52:55], v15 offset:34816
    ds_read_b128 a[72:75], v15 offset:52224
    ds_read_b128 a[76:79], v15 offset:53248
    ds_read_b128 a[96:99], v15 offset:12288
    ds_read_b128 a[100:103], v15 offset:13312
    ds_read_b128 a[120:123], v15 offset:15360
    ds_read_b128 a[124:127], v15 offset:16384
    ds_read_b128 a[144:147], v15 offset:39936
    ds_read_b128 a[148:151], v15 offset:40960
    s_waitcnt lgkmcnt(13)
    v_mfma_f32_16x16x32_bf16 v[120:123], a[224:227], a[0:3], 0
    s_lshl_b32 s42, s47, 7
    s_add_u32 s42, s42, s56
    s_add_u32 m0, s53, 0
    s_add_u32 s47, s47, 1
    s_cmp_eq_u32 s47, 7
    s_cselect_b32 s47, 0, s47
    s_waitcnt lgkmcnt(12)
    v_mfma_f32_16x16x32_bf16 v[124:127], a[224:227], a[4:7], 0
    buffer_load_dwordx4 v12, s[20:23], s42 offen  lds
    ds_read_b128 a[168:171], v15 offset:46080
    s_waitcnt lgkmcnt(12)
    v_mfma_f32_16x16x32_bf16 v[120:123], a[228:231], a[24:27], v[120:123]
    ds_read_b128 a[172:175], v15 offset:47104
    ds_read_b128 a[8:11], v15 offset:2048
    s_waitcnt lgkmcnt(13)
    v_mfma_f32_16x16x32_bf16 v[124:127], a[228:231], a[28:31], v[124:127]
    ds_read_b128 a[12:15], v15 offset:6144
    ds_read_b128 a[32:35], v15 offset:5120
    s_waitcnt lgkmcnt(14)
    v_mfma_f32_16x16x32_bf16 v[120:123], a[232:235], a[48:51], v[120:123]
    v_rcp_f32 v216, v216
    s_waitcnt lgkmcnt(13)
    v_mfma_f32_16x16x32_bf16 v[124:127], a[232:235], a[52:55], v[124:127]
    s_add_u32 m0, s53, 4096
    s_add_u32 s42, s42, 28672
    ds_read_b128 a[36:39], v15 offset:9216
    s_waitcnt lgkmcnt(13)
    v_mfma_f32_16x16x32_bf16 v[120:123], a[236:239], a[72:75], v[120:123]
    buffer_load_dwordx4 v12, s[20:23], s42 offen  lds
    ds_read_b128 a[56:59], v15 offset:35840
    s_waitcnt lgkmcnt(13)
    v_mfma_f32_16x16x32_bf16 v[124:127], a[236:239], a[76:79], v[124:127]
    v_rcp_f32 v217, v217
    s_waitcnt lgkmcnt(12)
    v_mfma_f32_16x16x32_bf16 v[120:123], a[240:243], a[96:99], v[120:123]
    ds_read_b128 a[60:63], v15 offset:36864
    ds_read_b128 a[80:83], v15 offset:54272
    s_waitcnt lgkmcnt(13)
    v_mfma_f32_16x16x32_bf16 v[124:127], a[240:243], a[100:103], v[124:127]
    v_rcp_f32 v218, v218
    s_waitcnt lgkmcnt(12)
    v_mfma_f32_16x16x32_bf16 v[120:123], a[244:247], a[120:123], v[120:123]
    ds_read_b128 a[84:87], v15 offset:55296
    ds_read_b128 a[104:107], v15 offset:14336
    s_waitcnt lgkmcnt(13)
    v_mfma_f32_16x16x32_bf16 v[124:127], a[244:247], a[124:127], v[124:127]
    v_rcp_f32 v219, v219
    v_rcp_f32 v220, v220
    v_rcp_f32 v221, v221
    s_add_u32 m0, s53, 8192
    s_add_u32 s42, s42, 28672
    s_waitcnt lgkmcnt(12)
    v_mfma_f32_16x16x32_bf16 v[120:123], a[248:251], a[144:147], v[120:123]
    buffer_load_dwordx4 v12, s[20:23], s42 offen  lds
    ds_read_b128 a[108:111], v15 offset:18432
    s_waitcnt lgkmcnt(12)
    v_mfma_f32_16x16x32_bf16 v[124:127], a[248:251], a[148:151], v[124:127]
    ds_read_b128 a[128:131], v15 offset:17408
    ds_read_b128 a[132:135], v15 offset:21504
    s_waitcnt lgkmcnt(13)
    v_mfma_f32_16x16x32_bf16 v[120:123], a[252:255], a[168:171], v[120:123]
    ds_read_b128 a[152:155], v15 offset:41984
    ds_read_b128 a[156:159], v15 offset:43008
    s_waitcnt lgkmcnt(14)
    v_mfma_f32_16x16x32_bf16 v[124:127], a[252:255], a[172:175], v[124:127]
    ds_read_b128 a[176:179], v15 offset:48128
    ds_read_b128 a[180:183], v15 offset:49152
    s_waitcnt lgkmcnt(15)
    v_mfma_f32_16x16x32_bf16 v[128:131], a[224:227], a[8:11], 0
    ds_read_b128 a[16:19], v15 offset:7168
    ds_read_b128 a[20:23], v15 offset:8192
    s_waitcnt lgkmcnt(15)
    v_mfma_f32_16x16x32_bf16 v[132:135], a[224:227], a[12:15], 0
    s_add_u32 m0, s53, 12288
    s_add_u32 s42, s42, 28672
    ds_read_b128 a[40:43], v15 offset:10240
    v_mfma_f32_16x16x32_bf16 v[128:131], a[228:231], a[32:35], v[128:131]
    buffer_load_dwordx4 v12, s[20:23], s42 offen  lds
    ds_read_b128 a[44:47], v15 offset:11264
    s_waitcnt lgkmcnt(15)
    v_mfma_f32_16x16x32_bf16 v[132:135], a[228:231], a[36:39], v[132:135]
    ds_read_b128 a[64:67], v15 offset:37888
    ds_read_b128 a[68:71], v15 offset:38912
    v_mfma_f32_16x16x32_bf16 v[128:131], a[232:235], a[56:59], v[128:131]
    s_mul_i32 s43, s48, 12288
    s_add_u32 s43, s43, s57
    ds_read_b128 a[88:91], v15 offset:56320
    s_waitcnt lgkmcnt(15)
    v_mfma_f32_16x16x32_bf16 v[132:135], a[232:235], a[60:63], v[132:135]
    s_add_u32 s48, s48, 1
    s_cmp_eq_u32 s48, 7
    s_cselect_b32 s48, 0, s48
    v_mfma_f32_16x16x32_bf16 v[128:131], a[236:239], a[80:83], v[128:131]
    ds_read_b128 a[92:95], v15 offset:57344
    v_mul_f32 v120, v120, v216
    v_mfma_f32_16x16x32_bf16 v[132:135], a[236:239], a[84:87], v[132:135]
    s_add_u32 m0, s53, 16384
    s_add_u32 s42, s42, 28672
    ds_read_b128 a[112:115], v15 offset:19456
    s_waitcnt lgkmcnt(15)
    v_mfma_f32_16x16x32_bf16 v[128:131], a[240:243], a[104:107], v[128:131]
    buffer_load_dwordx4 v12, s[20:23], s42 offen  lds
    v_mul_f32 v121, v121, v216
    v_mfma_f32_16x16x32_bf16 v[132:135], a[240:243], a[108:111], v[132:135]
    ds_read_b128 a[116:119], v15 offset:20480
    v_mul_f32 v122, v122, v216
    s_waitcnt lgkmcnt(15)
    v_mfma_f32_16x16x32_bf16 v[128:131], a[244:247], a[128:131], v[128:131]
    ds_read_b128 a[136:139], v15 offset:22528
    v_mul_f32 v123, v123, v216
    s_waitcnt lgkmcnt(15)
    v_mfma_f32_16x16x32_bf16 v[132:135], a[244:247], a[132:135], v[132:135]
    ds_read_b128 a[140:143], v15 offset:23552
    ds_read_b128 a[160:163], v15 offset:44032
    ds_read_b128 a[164:167], v15 offset:45056
    ds_read_b128 a[184:187], v15 offset:50176
    ds_read_b128 a[188:191], v15 offset:51200
    s_waitcnt lgkmcnt(15)
    v_mfma_f32_16x16x32_bf16 v[128:131], a[248:251], a[152:155], v[128:131]
    v_cvt_pk_bf16_f32 v80, v120, v121
    v_cvt_pk_bf16_f32 v81, v122, v123
    v_mfma_f32_16x16x32_bf16 v[132:135], a[248:251], a[156:159], v[132:135]
    v_mul_f32 v124, v124, v217
    v_mul_f32 v125, v125, v217
    v_mul_f32 v126, v126, v217
    v_mul_f32 v127, v127, v217
    v_cvt_pk_bf16_f32 v82, v124, v125
    v_cvt_pk_bf16_f32 v83, v126, v127
    buffer_store_dwordx4 v[80:83], v240, s[24:27], s43 offen sc1
    s_add_u32 m0, s53, 20480
    s_add_u32 s42, s42, 28672
    v_mfma_f32_16x16x32_bf16 v[128:131], a[252:255], a[176:179], v[128:131]
    buffer_load_dwordx4 v12, s[20:23], s42 offen  lds
    v_mfma_f32_16x16x32_bf16 v[132:135], a[252:255], a[180:183], v[132:135]
    ds_read_b64_tr_b16 a[192:193], v25 offset:0
    ds_read_b64_tr_b16 a[194:195], v25 offset:2048
    v_mfma_f32_16x16x32_bf16 v[136:139], a[224:227], a[16:19], 0
    ds_read_b64_tr_b16 a[196:197], v25 offset:4096
    ds_read_b64_tr_b16 a[198:199], v25 offset:6144
    s_waitcnt lgkmcnt(15)
    v_mfma_f32_16x16x32_bf16 v[140:143], a[224:227], a[20:23], 0
    ds_read_b64_tr_b16 a[200:201], v25 offset:8192
    ds_read_b64_tr_b16 a[202:203], v25 offset:10240
    v_mfma_f32_16x16x32_bf16 v[136:139], a[228:231], a[40:43], v[136:139]
    ds_read_b64_tr_b16 a[204:205], v25 offset:12288
    ds_read_b64_tr_b16 a[206:207], v25 offset:14336
    v_mfma_f32_16x16x32_bf16 v[140:143], a[228:231], a[44:47], v[140:143]
    s_add_u32 m0, s53, 24576
    s_add_u32 s42, s42, 28672
    v_mfma_f32_16x16x32_bf16 v[136:139], a[232:235], a[64:67], v[136:139]
    buffer_load_dwordx4 v12, s[20:23], s42 offen  lds
    s_waitcnt lgkmcnt(15)
    v_mfma_f32_16x16x32_bf16 v[140:143], a[232:235], a[68:71], v[140:143]
    v_mul_f32 v128, v128, v218
    v_mul_f32 v129, v129, v218
    v_mfma_f32_16x16x32_bf16 v[136:139], a[236:239], a[88:91], v[136:139]
    v_mul_f32 v130, v130, v218
    ds_read_b64_tr_b16 a[208:209], v25 offset:16384
    v_mfma_f32_16x16x32_bf16 v[140:143], a[236:239], a[92:95], v[140:143]
    v_mul_f32 v131, v131, v218
    ds_read_b64_tr_b16 a[210:211], v25 offset:18432
    v_mfma_f32_16x16x32_bf16 v[136:139], a[240:243], a[112:115], v[136:139]
    v_cvt_pk_bf16_f32 v84, v128, v129
    v_cvt_pk_bf16_f32 v85, v130, v131
    s_waitcnt lgkmcnt(15)
    v_mfma_f32_16x16x32_bf16 v[140:143], a[240:243], a[116:119], v[140:143]
    s_add_u32 m0, s53, 28672
    s_add_u32 s42, s42, 28672
    v_mfma_f32_16x16x32_bf16 v[136:139], a[244:247], a[136:139], v[136:139]
    buffer_load_dwordx4 v12, s[20:23], s42 offen  lds
    ds_read_b64_tr_b16 a[212:213], v25 offset:20480
    s_waitcnt lgkmcnt(15)
    v_mfma_f32_16x16x32_bf16 v[140:143], a[244:247], a[140:143], v[140:143]
    v_mul_f32 v132, v132, v219
    ds_read_b64_tr_b16 a[214:215], v25 offset:22528
    s_waitcnt lgkmcnt(15)
    v_mfma_f32_16x16x32_bf16 v[136:139], a[248:251], a[160:163], v[136:139]
    v_mul_f32 v133, v133, v219
    ds_read_b64_tr_b16 a[216:217], v25 offset:24576
    s_waitcnt lgkmcnt(15)
    v_mfma_f32_16x16x32_bf16 v[140:143], a[248:251], a[164:167], v[140:143]
    v_mul_f32 v134, v134, v219
    v_mul_f32 v135, v135, v219
    ds_read_b64_tr_b16 a[218:219], v25 offset:26624
    v_cvt_pk_bf16_f32 v86, v132, v133
    ds_read_b64_tr_b16 a[220:221], v25 offset:28672
    v_cvt_pk_bf16_f32 v87, v134, v135
    buffer_store_dwordx4 v[84:87], v241, s[24:27], s43 offen sc1
    ds_read_b64_tr_b16 a[222:223], v25 offset:30720
    s_waitcnt lgkmcnt(15)
    v_mfma_f32_16x16x32_bf16 v[136:139], a[252:255], a[184:187], v[136:139]
    v_mfma_f32_16x16x32_bf16 v[140:143], a[252:255], a[188:191], v[140:143]
    s_waitcnt lgkmcnt(14)
    v_mfma_f32_16x16x32_bf16 v[144:147], a[192:195], a[0:3], 0
    v_mfma_f32_16x16x32_bf16 v[148:151], a[192:195], a[4:7], 0
    s_waitcnt lgkmcnt(12)
    v_mfma_f32_16x16x32_bf16 v[144:147], a[196:199], a[24:27], v[144:147]
    v_mfma_f32_16x16x32_bf16 v[148:151], a[196:199], a[28:31], v[148:151]
    s_nop 0
    v_mul_f32 v136, v136, v220
    v_mul_f32 v137, v137, v220
    s_waitcnt lgkmcnt(10)
    v_mfma_f32_16x16x32_bf16 v[144:147], a[200:203], a[48:51], v[144:147]
    v_mul_f32 v138, v138, v220
    v_mul_f32 v139, v139, v220
    v_mfma_f32_16x16x32_bf16 v[148:151], a[200:203], a[52:55], v[148:151]
    v_cvt_pk_bf16_f32 v88, v136, v137
    v_cvt_pk_bf16_f32 v89, v138, v139
    s_waitcnt lgkmcnt(8)
    v_mfma_f32_16x16x32_bf16 v[144:147], a[204:207], a[72:75], v[144:147]
    v_mul_f32 v140, v140, v221
    v_mul_f32 v141, v141, v221
    v_mfma_f32_16x16x32_bf16 v[148:151], a[204:207], a[76:79], v[148:151]
    v_mul_f32 v142, v142, v221
    v_mul_f32 v143, v143, v221
    s_waitcnt lgkmcnt(6)
    v_mfma_f32_16x16x32_bf16 v[144:147], a[208:211], a[96:99], v[144:147]
    v_cvt_pk_bf16_f32 v90, v140, v141
    v_cvt_pk_bf16_f32 v91, v142, v143
    v_mfma_f32_16x16x32_bf16 v[148:151], a[208:211], a[100:103], v[148:151]
    buffer_store_dwordx4 v[88:91], v242, s[24:27], s43 offen sc1
    s_waitcnt lgkmcnt(4)
    v_mfma_f32_16x16x32_bf16 v[144:147], a[212:215], a[120:123], v[144:147]
    v_mfma_f32_16x16x32_bf16 v[148:151], a[212:215], a[124:127], v[148:151]
    s_waitcnt lgkmcnt(2)
    v_mfma_f32_16x16x32_bf16 v[144:147], a[216:219], a[144:147], v[144:147]
    v_mfma_f32_16x16x32_bf16 v[148:151], a[216:219], a[148:151], v[148:151]
    s_waitcnt lgkmcnt(0)
    v_mfma_f32_16x16x32_bf16 v[144:147], a[220:223], a[168:171], v[144:147]
    v_mfma_f32_16x16x32_bf16 v[148:151], a[220:223], a[172:175], v[148:151]
    v_mfma_f32_16x16x32_bf16 v[152:155], a[192:195], a[8:11], 0
    v_mfma_f32_16x16x32_bf16 v[156:159], a[192:195], a[12:15], 0
    v_mfma_f32_16x16x32_bf16 v[152:155], a[196:199], a[32:35], v[152:155]
    v_mfma_f32_16x16x32_bf16 v[156:159], a[196:199], a[36:39], v[156:159]
    s_mul_i32 s43, s48, 12288
    s_add_u32 s43, s43, s57
    v_mfma_f32_16x16x32_bf16 v[152:155], a[200:203], a[56:59], v[152:155]
    s_add_u32 s48, s48, 1
    s_cmp_eq_u32 s48, 7
    s_cselect_b32 s48, 0, s48
    v_mfma_f32_16x16x32_bf16 v[156:159], a[200:203], a[60:63], v[156:159]
    s_lshl_b32 s42, s47, 7
    s_add_u32 s42, s42, s56
    s_add_u32 m0, s53, 33792
    s_add_u32 s47, s47, 1
    s_cmp_eq_u32 s47, 7
    s_cselect_b32 s47, 0, s47
    v_mfma_f32_16x16x32_bf16 v[152:155], a[204:207], a[80:83], v[152:155]
    buffer_load_dwordx4 v12, s[20:23], s42 offen  lds
    v_mul_f32 v144, v144, v216
    v_mfma_f32_16x16x32_bf16 v[156:159], a[204:207], a[84:87], v[156:159]
    s_waitcnt vmcnt(12)
    s_barrier
    v_mfma_f32_16x16x32_bf16 v[152:155], a[208:211], a[104:107], v[152:155]
    s_add_u32 m0, s53, 37888
    s_add_u32 s42, s42, 28672
    v_mul_f32 v145, v145, v216
    v_mfma_f32_16x16x32_bf16 v[156:159], a[208:211], a[108:111], v[156:159]
    buffer_load_dwordx4 v12, s[20:23], s42 offen  lds
    ds_read_b64_tr_b16 a[224:225], v26 offset:0
    v_mfma_f32_16x16x32_bf16 v[152:155], a[212:215], a[128:131], v[152:155]
    v_mul_f32 v146, v146, v216
    v_mul_f32 v147, v147, v216
    v_mfma_f32_16x16x32_bf16 v[156:159], a[212:215], a[132:135], v[156:159]
    s_add_u32 m0, s53, 41984
    s_add_u32 s42, s42, 28672
    v_cvt_pk_bf16_f32 v92, v144, v145
    v_mfma_f32_16x16x32_bf16 v[152:155], a[216:219], a[152:155], v[152:155]
    buffer_load_dwordx4 v12, s[20:23], s42 offen  lds
    ds_read_b64_tr_b16 a[226:227], v26 offset:2048
    v_mfma_f32_16x16x32_bf16 v[156:159], a[216:219], a[156:159], v[156:159]
    v_cvt_pk_bf16_f32 v93, v146, v147
    v_mul_f32 v148, v148, v217
    v_mul_f32 v149, v149, v217
    v_mul_f32 v150, v150, v217
    v_mul_f32 v151, v151, v217
    v_cvt_pk_bf16_f32 v94, v148, v149
    v_cvt_pk_bf16_f32 v95, v150, v151
    buffer_store_dwordx4 v[92:95], v240, s[24:27], s43 offen sc1
    v_mfma_f32_16x16x32_bf16 v[152:155], a[220:223], a[176:179], v[152:155]
    ds_read_b64_tr_b16 a[228:229], v26 offset:4096
    s_add_u32 m0, s53, 46080
    s_add_u32 s42, s42, 28672
    v_mfma_f32_16x16x32_bf16 v[156:159], a[220:223], a[180:183], v[156:159]
    ds_read_b64_tr_b16 a[230:231], v26 offset:6144
    buffer_load_dwordx4 v12, s[20:23], s42 offen  lds
    v_mfma_f32_16x16x32_bf16 v[160:163], a[192:195], a[16:19], 0
    ds_read_b64_tr_b16 a[232:233], v26 offset:8192
    ds_read_b64_tr_b16 a[234:235], v26 offset:10240
    v_mfma_f32_16x16x32_bf16 v[164:167], a[192:195], a[20:23], 0
    ds_read_b64_tr_b16 a[236:237], v26 offset:12288
    ds_read_b64_tr_b16 a[238:239], v26 offset:14336
    v_mfma_f32_16x16x32_bf16 v[160:163], a[196:199], a[40:43], v[160:163]
    s_add_u32 m0, s53, 50176
    s_add_u32 s42, s42, 28672
    ds_read_b64_tr_b16 a[240:241], v26 offset:16384
    v_mfma_f32_16x16x32_bf16 v[164:167], a[196:199], a[44:47], v[164:167]
    buffer_load_dwordx4 v12, s[20:23], s42 offen  lds
    ds_read_b64_tr_b16 a[242:243], v26 offset:18432
    v_mfma_f32_16x16x32_bf16 v[160:163], a[200:203], a[64:67], v[160:163]
    v_mul_f32 v152, v152, v218
    v_mul_f32 v153, v153, v218
    v_mfma_f32_16x16x32_bf16 v[164:167], a[200:203], a[68:71], v[164:167]
    s_add_u32 m0, s53, 54272
    s_add_u32 s42, s42, 28672
    ds_read_b64_tr_b16 a[244:245], v26 offset:20480
    v_mfma_f32_16x16x32_bf16 v[160:163], a[204:207], a[88:91], v[160:163]
    buffer_load_dwordx4 v12, s[20:23], s42 offen  lds
    v_mul_f32 v154, v154, v218
    v_mfma_f32_16x16x32_bf16 v[164:167], a[204:207], a[92:95], v[164:167]
    ds_read_b64_tr_b16 a[246:247], v26 offset:22528
    v_mul_f32 v155, v155, v218
    v_mfma_f32_16x16x32_bf16 v[160:163], a[208:211], a[112:115], v[160:163]
    s_add_u32 m0, s53, 58368
    s_add_u32 s42, s42, 28672
    v_cvt_pk_bf16_f32 v96, v152, v153
    v_mfma_f32_16x16x32_bf16 v[164:167], a[208:211], a[116:119], v[164:167]
    buffer_load_dwordx4 v12, s[20:23], s42 offen  lds
    ds_read_b64_tr_b16 a[248:249], v26 offset:24576
    v_mfma_f32_16x16x32_bf16 v[160:163], a[212:215], a[136:139], v[160:163]
    v_cvt_pk_bf16_f32 v97, v154, v155
    v_mul_f32 v156, v156, v219
    v_mfma_f32_16x16x32_bf16 v[164:167], a[212:215], a[140:143], v[164:167]
    ds_read_b64_tr_b16 a[250:251], v26 offset:26624
    ds_read_b64_tr_b16 a[252:253], v26 offset:28672
    ds_read_b64_tr_b16 a[254:255], v26 offset:30720
    s_add_u32 m0, s53, 62464
    s_add_u32 s42, s42, 28672
    v_mfma_f32_16x16x32_bf16 v[160:163], a[216:219], a[160:163], v[160:163]
    buffer_load_dwordx4 v12, s[20:23], s42 offen  lds
    v_mfma_f32_16x16x32_bf16 v[164:167], a[216:219], a[164:167], v[164:167]
    v_mul_f32 v157, v157, v219
    v_mul_f32 v158, v158, v219
    v_mul_f32 v159, v159, v219
    v_cvt_pk_bf16_f32 v98, v156, v157
    v_cvt_pk_bf16_f32 v99, v158, v159
    buffer_store_dwordx4 v[96:99], v241, s[24:27], s43 offen sc1
    v_mfma_f32_16x16x32_bf16 v[160:163], a[220:223], a[184:187], v[160:163]
    v_mfma_f32_16x16x32_bf16 v[164:167], a[220:223], a[188:191], v[164:167]
    s_waitcnt lgkmcnt(14)
    v_mfma_f32_16x16x32_bf16 v[32:35], a[224:227], a[0:3], 0
    s_lshl_b32 s42, s47, 7
    s_add_u32 s42, s42, s56
    s_add_u32 m0, s53, 101376
    s_add_u32 s47, s47, 1
    s_cmp_eq_u32 s47, 7
    s_cselect_b32 s47, 0, s47
    v_mfma_f32_16x16x32_bf16 v[36:39], a[224:227], a[4:7], 0
    buffer_load_dwordx4 v12, s[20:23], s42 offen  lds
    s_waitcnt lgkmcnt(12)
    v_mfma_f32_16x16x32_bf16 v[32:35], a[228:231], a[24:27], v[32:35]
    v_mfma_f32_16x16x32_bf16 v[36:39], a[228:231], a[28:31], v[36:39]
    v_mul_f32 v160, v160, v220
    v_mul_f32 v161, v161, v220
    s_waitcnt lgkmcnt(10)
    v_mfma_f32_16x16x32_bf16 v[32:35], a[232:235], a[48:51], v[32:35]
    v_mul_f32 v162, v162, v220
    v_mul_f32 v163, v163, v220
    v_mfma_f32_16x16x32_bf16 v[36:39], a[232:235], a[52:55], v[36:39]
    s_add_u32 m0, s53, 105472
    s_add_u32 s42, s42, 28672
    s_waitcnt lgkmcnt(8)
    v_mfma_f32_16x16x32_bf16 v[32:35], a[236:239], a[72:75], v[32:35]
    buffer_load_dwordx4 v12, s[20:23], s42 offen  lds
    v_mfma_f32_16x16x32_bf16 v[36:39], a[236:239], a[76:79], v[36:39]
    v_cvt_pk_bf16_f32 v100, v160, v161
    v_cvt_pk_bf16_f32 v101, v162, v163
    s_waitcnt lgkmcnt(6)
    v_mfma_f32_16x16x32_bf16 v[32:35], a[240:243], a[96:99], v[32:35]
    v_mul_f32 v164, v164, v221
    v_mul_f32 v165, v165, v221
    v_mfma_f32_16x16x32_bf16 v[36:39], a[240:243], a[100:103], v[36:39]
    v_mul_f32 v166, v166, v221
    v_mul_f32 v167, v167, v221
    s_waitcnt lgkmcnt(4)
    v_mfma_f32_16x16x32_bf16 v[32:35], a[244:247], a[120:123], v[32:35]
    v_cvt_pk_bf16_f32 v102, v164, v165
    v_cvt_pk_bf16_f32 v103, v166, v167
    v_mfma_f32_16x16x32_bf16 v[36:39], a[244:247], a[124:127], v[36:39]
    s_add_u32 m0, s53, 109568
    s_add_u32 s42, s42, 28672
    s_waitcnt lgkmcnt(2)
    v_mfma_f32_16x16x32_bf16 v[32:35], a[248:251], a[144:147], v[32:35]
    buffer_load_dwordx4 v12, s[20:23], s42 offen  lds
    v_mfma_f32_16x16x32_bf16 v[36:39], a[248:251], a[148:151], v[36:39]
    buffer_store_dwordx4 v[100:103], v242, s[24:27], s43 offen sc1
    s_waitcnt lgkmcnt(0)
    v_mfma_f32_16x16x32_bf16 v[32:35], a[252:255], a[168:171], v[32:35]
    v_mfma_f32_16x16x32_bf16 v[36:39], a[252:255], a[172:175], v[36:39]
    v_mfma_f32_16x16x32_bf16 v[40:43], a[224:227], a[8:11], 0
    v_mfma_f32_16x16x32_bf16 v[44:47], a[224:227], a[12:15], 0
    s_add_u32 m0, s53, 113664
    s_add_u32 s42, s42, 28672
    v_mfma_f32_16x16x32_bf16 v[40:43], a[228:231], a[32:35], v[40:43]
    buffer_load_dwordx4 v12, s[20:23], s42 offen  lds
    v_mfma_f32_16x16x32_bf16 v[44:47], a[228:231], a[36:39], v[44:47]
    s_mul_i32 s43, s48, 12288
    s_add_u32 s43, s43, s57
    v_mfma_f32_16x16x32_bf16 v[40:43], a[232:235], a[56:59], v[40:43]
    s_add_u32 s48, s48, 1
    s_cmp_eq_u32 s48, 7
    s_cselect_b32 s48, 0, s48
    v_mfma_f32_16x16x32_bf16 v[44:47], a[232:235], a[60:63], v[44:47]
    s_waitcnt vmcnt(17)
    s_barrier
    v_mfma_f32_16x16x32_bf16 v[40:43], a[236:239], a[80:83], v[40:43]
    v_mul_f32 v32, v32, v216
    v_mul_f32 v33, v33, v216
    v_mfma_f32_16x16x32_bf16 v[44:47], a[236:239], a[84:87], v[44:47]
    s_add_u32 m0, s53, 117760
    s_add_u32 s42, s42, 28672
    v_mfma_f32_16x16x32_bf16 v[40:43], a[240:243], a[104:107], v[40:43]
    buffer_load_dwordx4 v12, s[20:23], s42 offen  lds
    v_mfma_f32_16x16x32_bf16 v[44:47], a[240:243], a[108:111], v[44:47]
    ds_read_b64_tr_b16 a[192:193], v24 offset:0
    v_mul_f32 v34, v34, v216
    v_mfma_f32_16x16x32_bf16 v[40:43], a[244:247], a[128:131], v[40:43]
    v_mul_f32 v35, v35, v216
    v_cvt_pk_bf16_f32 v80, v32, v33
    v_mfma_f32_16x16x32_bf16 v[44:47], a[244:247], a[132:135], v[44:47]
    ds_read_b64_tr_b16 a[194:195], v24 offset:2048
    v_cvt_pk_bf16_f32 v81, v34, v35
    v_mfma_f32_16x16x32_bf16 v[40:43], a[248:251], a[152:155], v[40:43]
    v_mul_f32 v36, v36, v217
    ds_read_b64_tr_b16 a[196:197], v24 offset:4096
    v_mfma_f32_16x16x32_bf16 v[44:47], a[248:251], a[156:159], v[44:47]
    v_mul_f32 v37, v37, v217
    v_mul_f32 v38, v38, v217
    v_mul_f32 v39, v39, v217
    v_cvt_pk_bf16_f32 v82, v36, v37
    v_cvt_pk_bf16_f32 v83, v38, v39
    buffer_store_dwordx4 v[80:83], v240, s[24:27], s43 offen sc1
    s_add_u32 m0, s53, 121856
    s_add_u32 s42, s42, 28672
    v_mfma_f32_16x16x32_bf16 v[40:43], a[252:255], a[176:179], v[40:43]
    buffer_load_dwordx4 v12, s[20:23], s42 offen  lds
    v_mfma_f32_16x16x32_bf16 v[44:47], a[252:255], a[180:183], v[44:47]
    ds_read_b64_tr_b16 a[198:199], v24 offset:6144
    ds_read_b64_tr_b16 a[200:201], v24 offset:8192
    v_mfma_f32_16x16x32_bf16 v[48:51], a[224:227], a[16:19], 0
    ds_read_b64_tr_b16 a[202:203], v24 offset:10240
    ds_read_b64_tr_b16 a[204:205], v24 offset:12288
    v_mfma_f32_16x16x32_bf16 v[52:55], a[224:227], a[20:23], 0
    ds_read_b64_tr_b16 a[206:207], v24 offset:14336
    ds_read_b64_tr_b16 a[208:209], v24 offset:16384
    v_mfma_f32_16x16x32_bf16 v[48:51], a[228:231], a[40:43], v[48:51]
    ds_read_b64_tr_b16 a[210:211], v24 offset:18432
    ds_read_b64_tr_b16 a[212:213], v24 offset:20480
    v_mfma_f32_16x16x32_bf16 v[52:55], a[228:231], a[44:47], v[52:55]
    s_add_u32 m0, s53, 125952
    s_add_u32 s42, s42, 28672
    v_mfma_f32_16x16x32_bf16 v[48:51], a[232:235], a[64:67], v[48:51]
    buffer_load_dwordx4 v12, s[20:23], s42 offen  lds
    v_mfma_f32_16x16x32_bf16 v[52:55], a[232:235], a[68:71], v[52:55]
    v_mul_f32 v40, v40, v218
    v_mul_f32 v41, v41, v218
    v_mfma_f32_16x16x32_bf16 v[48:51], a[236:239], a[88:91], v[48:51]
    v_mul_f32 v42, v42, v218
    ds_read_b64_tr_b16 a[214:215], v24 offset:22528
    v_mfma_f32_16x16x32_bf16 v[52:55], a[236:239], a[92:95], v[52:55]
    v_mul_f32 v43, v43, v218
    v_cvt_pk_bf16_f32 v84, v40, v41
    v_mfma_f32_16x16x32_bf16 v[48:51], a[240:243], a[112:115], v[48:51]
    ds_read_b64_tr_b16 a[216:217], v24 offset:24576
    v_cvt_pk_bf16_f32 v85, v42, v43
    v_mfma_f32_16x16x32_bf16 v[52:55], a[240:243], a[116:119], v[52:55]
    s_add_u32 m0, s53, 130048
    s_add_u32 s42, s42, 28672
    v_mfma_f32_16x16x32_bf16 v[48:51], a[244:247], a[136:139], v[48:51]
    buffer_load_dwordx4 v12, s[20:23], s42 offen  lds
    v_mfma_f32_16x16x32_bf16 v[52:55], a[244:247], a[140:143], v[52:55]
    ds_read_b64_tr_b16 a[218:219], v24 offset:26624
    ds_read_b64_tr_b16 a[220:221], v24 offset:28672
    ds_read_b64_tr_b16 a[222:223], v24 offset:30720
    v_mfma_f32_16x16x32_bf16 v[48:51], a[248:251], a[160:163], v[48:51]
    v_mul_f32 v44, v44, v219
    v_mul_f32 v45, v45, v219
    v_mfma_f32_16x16x32_bf16 v[52:55], a[248:251], a[164:167], v[52:55]
    v_mul_f32 v46, v46, v219
    v_mul_f32 v47, v47, v219
    v_cvt_pk_bf16_f32 v86, v44, v45
    v_cvt_pk_bf16_f32 v87, v46, v47
    buffer_store_dwordx4 v[84:87], v241, s[24:27], s43 offen sc1
    v_mfma_f32_16x16x32_bf16 v[48:51], a[252:255], a[184:187], v[48:51]
    v_mfma_f32_16x16x32_bf16 v[52:55], a[252:255], a[188:191], v[52:55]
    s_waitcnt lgkmcnt(14)
    v_mfma_f32_16x16x32_bf16 v[120:123], a[192:195], a[0:3], 0
    s_lshl_b32 s42, s47, 7
    s_add_u32 s42, s42, s56
    s_add_u32 m0, s53, 67584
    s_add_u32 s47, s47, 1
    s_cmp_eq_u32 s47, 7
    s_cselect_b32 s47, 0, s47
    v_mfma_f32_16x16x32_bf16 v[124:127], a[192:195], a[4:7], 0
    buffer_load_dwordx4 v12, s[20:23], s42 offen  lds
    s_waitcnt lgkmcnt(12)
    v_mfma_f32_16x16x32_bf16 v[120:123], a[196:199], a[24:27], v[120:123]
    v_mfma_f32_16x16x32_bf16 v[124:127], a[196:199], a[28:31], v[124:127]
    v_mul_f32 v48, v48, v220
    v_mul_f32 v49, v49, v220
    s_waitcnt lgkmcnt(10)
    v_mfma_f32_16x16x32_bf16 v[120:123], a[200:203], a[48:51], v[120:123]
    v_mul_f32 v50, v50, v220
    v_mul_f32 v51, v51, v220
    v_mfma_f32_16x16x32_bf16 v[124:127], a[200:203], a[52:55], v[124:127]
    s_add_u32 m0, s53, 71680
    s_add_u32 s42, s42, 28672
    s_waitcnt lgkmcnt(8)
    v_mfma_f32_16x16x32_bf16 v[120:123], a[204:207], a[72:75], v[120:123]
    buffer_load_dwordx4 v12, s[20:23], s42 offen  lds
    v_mfma_f32_16x16x32_bf16 v[124:127], a[204:207], a[76:79], v[124:127]
    v_cvt_pk_bf16_f32 v88, v48, v49
    v_cvt_pk_bf16_f32 v89, v50, v51
    s_waitcnt lgkmcnt(6)
    v_mfma_f32_16x16x32_bf16 v[120:123], a[208:211], a[96:99], v[120:123]
    v_mul_f32 v52, v52, v221
    v_mul_f32 v53, v53, v221
    v_mfma_f32_16x16x32_bf16 v[124:127], a[208:211], a[100:103], v[124:127]
    v_mul_f32 v54, v54, v221
    v_mul_f32 v55, v55, v221
    s_waitcnt lgkmcnt(4)
    v_mfma_f32_16x16x32_bf16 v[120:123], a[212:215], a[120:123], v[120:123]
    v_cvt_pk_bf16_f32 v90, v52, v53
    v_cvt_pk_bf16_f32 v91, v54, v55
    v_mfma_f32_16x16x32_bf16 v[124:127], a[212:215], a[124:127], v[124:127]
    s_add_u32 m0, s53, 75776
    s_add_u32 s42, s42, 28672
    s_waitcnt lgkmcnt(2)
    v_mfma_f32_16x16x32_bf16 v[120:123], a[216:219], a[144:147], v[120:123]
    buffer_load_dwordx4 v12, s[20:23], s42 offen  lds
    v_mfma_f32_16x16x32_bf16 v[124:127], a[216:219], a[148:151], v[124:127]
    buffer_store_dwordx4 v[88:91], v242, s[24:27], s43 offen sc1
    s_waitcnt lgkmcnt(0)
    v_mfma_f32_16x16x32_bf16 v[120:123], a[220:223], a[168:171], v[120:123]
    v_mfma_f32_16x16x32_bf16 v[124:127], a[220:223], a[172:175], v[124:127]
    v_mfma_f32_16x16x32_bf16 v[128:131], a[192:195], a[8:11], 0
    v_mfma_f32_16x16x32_bf16 v[132:135], a[192:195], a[12:15], 0
    s_add_u32 m0, s53, 79872
    s_add_u32 s42, s42, 28672
    v_mfma_f32_16x16x32_bf16 v[128:131], a[196:199], a[32:35], v[128:131]
    buffer_load_dwordx4 v12, s[20:23], s42 offen  lds
    v_mfma_f32_16x16x32_bf16 v[132:135], a[196:199], a[36:39], v[132:135]
    s_mul_i32 s43, s48, 12288
    s_add_u32 s43, s43, s57
    v_mfma_f32_16x16x32_bf16 v[128:131], a[200:203], a[56:59], v[128:131]
    s_add_u32 s48, s48, 1
    s_cmp_eq_u32 s48, 7
    s_cselect_b32 s48, 0, s48
    v_mfma_f32_16x16x32_bf16 v[132:135], a[200:203], a[60:63], v[132:135]
    s_waitcnt vmcnt(17)
    s_barrier
    v_mfma_f32_16x16x32_bf16 v[128:131], a[204:207], a[80:83], v[128:131]
    v_mul_f32 v120, v120, v216
    v_mul_f32 v121, v121, v216
    v_mfma_f32_16x16x32_bf16 v[132:135], a[204:207], a[84:87], v[132:135]
    s_add_u32 m0, s53, 83968
    s_add_u32 s42, s42, 28672
    v_mfma_f32_16x16x32_bf16 v[128:131], a[208:211], a[104:107], v[128:131]
    buffer_load_dwordx4 v12, s[20:23], s42 offen  lds
    v_mfma_f32_16x16x32_bf16 v[132:135], a[208:211], a[108:111], v[132:135]
    ds_read_b64_tr_b16 a[224:225], v25 offset:0
    v_mul_f32 v122, v122, v216
    v_mfma_f32_16x16x32_bf16 v[128:131], a[212:215], a[128:131], v[128:131]
    v_mul_f32 v123, v123, v216
    v_cvt_pk_bf16_f32 v92, v120, v121
    v_mfma_f32_16x16x32_bf16 v[132:135], a[212:215], a[132:135], v[132:135]
    ds_read_b64_tr_b16 a[226:227], v25 offset:2048
    v_cvt_pk_bf16_f32 v93, v122, v123
    v_mfma_f32_16x16x32_bf16 v[128:131], a[216:219], a[152:155], v[128:131]
    v_mul_f32 v124, v124, v217
    ds_read_b64_tr_b16 a[228:229], v25 offset:4096
    v_mfma_f32_16x16x32_bf16 v[132:135], a[216:219], a[156:159], v[132:135]
    v_mul_f32 v125, v125, v217
    v_mul_f32 v126, v126, v217
    v_mul_f32 v127, v127, v217
    v_cvt_pk_bf16_f32 v94, v124, v125
    v_cvt_pk_bf16_f32 v95, v126, v127
    buffer_store_dwordx4 v[92:95], v240, s[24:27], s43 offen sc1
    s_add_u32 m0, s53, 88064
    s_add_u32 s42, s42, 28672
    v_mfma_f32_16x16x32_bf16 v[128:131], a[220:223], a[176:179], v[128:131]
    buffer_load_dwordx4 v12, s[20:23], s42 offen  lds
    v_mfma_f32_16x16x32_bf16 v[132:135], a[220:223], a[180:183], v[132:135]
    ds_read_b64_tr_b16 a[230:231], v25 offset:6144
    ds_read_b64_tr_b16 a[232:233], v25 offset:8192
    v_mfma_f32_16x16x32_bf16 v[136:139], a[192:195], a[16:19], 0
    ds_read_b64_tr_b16 a[234:235], v25 offset:10240
    ds_read_b64_tr_b16 a[236:237], v25 offset:12288
    v_mfma_f32_16x16x32_bf16 v[140:143], a[192:195], a[20:23], 0
    ds_read_b64_tr_b16 a[238:239], v25 offset:14336
    ds_read_b64_tr_b16 a[240:241], v25 offset:16384
    v_mfma_f32_16x16x32_bf16 v[136:139], a[196:199], a[40:43], v[136:139]
    ds_read_b64_tr_b16 a[242:243], v25 offset:18432
    ds_read_b64_tr_b16 a[244:245], v25 offset:20480
    v_mfma_f32_16x16x32_bf16 v[140:143], a[196:199], a[44:47], v[140:143]
    s_add_u32 m0, s53, 92160
    s_add_u32 s42, s42, 28672
    v_mfma_f32_16x16x32_bf16 v[136:139], a[200:203], a[64:67], v[136:139]
    buffer_load_dwordx4 v12, s[20:23], s42 offen  lds
    v_mfma_f32_16x16x32_bf16 v[140:143], a[200:203], a[68:71], v[140:143]
    v_mul_f32 v128, v128, v218
    v_mul_f32 v129, v129, v218
    v_mfma_f32_16x16x32_bf16 v[136:139], a[204:207], a[88:91], v[136:139]
    v_mul_f32 v130, v130, v218
    ds_read_b64_tr_b16 a[246:247], v25 offset:22528
    v_mfma_f32_16x16x32_bf16 v[140:143], a[204:207], a[92:95], v[140:143]
    v_mul_f32 v131, v131, v218
    v_cvt_pk_bf16_f32 v96, v128, v129
    v_mfma_f32_16x16x32_bf16 v[136:139], a[208:211], a[112:115], v[136:139]
    ds_read_b64_tr_b16 a[248:249], v25 offset:24576
    v_cvt_pk_bf16_f32 v97, v130, v131
    v_mfma_f32_16x16x32_bf16 v[140:143], a[208:211], a[116:119], v[140:143]
    s_add_u32 m0, s53, 96256
    s_add_u32 s42, s42, 28672
    v_mfma_f32_16x16x32_bf16 v[136:139], a[212:215], a[136:139], v[136:139]
    buffer_load_dwordx4 v12, s[20:23], s42 offen  lds
    v_mfma_f32_16x16x32_bf16 v[140:143], a[212:215], a[140:143], v[140:143]
    ds_read_b64_tr_b16 a[250:251], v25 offset:26624
    ds_read_b64_tr_b16 a[252:253], v25 offset:28672
    ds_read_b64_tr_b16 a[254:255], v25 offset:30720
    v_mfma_f32_16x16x32_bf16 v[136:139], a[216:219], a[160:163], v[136:139]
    v_mul_f32 v132, v132, v219
    v_mul_f32 v133, v133, v219
    v_mfma_f32_16x16x32_bf16 v[140:143], a[216:219], a[164:167], v[140:143]
    v_mul_f32 v134, v134, v219
    v_mul_f32 v135, v135, v219
    v_cvt_pk_bf16_f32 v98, v132, v133
    v_cvt_pk_bf16_f32 v99, v134, v135
    buffer_store_dwordx4 v[96:99], v241, s[24:27], s43 offen sc1
    v_mfma_f32_16x16x32_bf16 v[136:139], a[220:223], a[184:187], v[136:139]
    v_mfma_f32_16x16x32_bf16 v[140:143], a[220:223], a[188:191], v[140:143]
    s_waitcnt lgkmcnt(14)
    v_mfma_f32_16x16x32_bf16 v[144:147], a[224:227], a[0:3], 0
    v_mfma_f32_16x16x32_bf16 v[148:151], a[224:227], a[4:7], 0
    s_waitcnt lgkmcnt(12)
    v_mfma_f32_16x16x32_bf16 v[144:147], a[228:231], a[24:27], v[144:147]
    v_mfma_f32_16x16x32_bf16 v[148:151], a[228:231], a[28:31], v[148:151]
    s_nop 0
    v_mul_f32 v136, v136, v220
    v_mul_f32 v137, v137, v220
    s_waitcnt lgkmcnt(10)
    v_mfma_f32_16x16x32_bf16 v[144:147], a[232:235], a[48:51], v[144:147]
    v_mul_f32 v138, v138, v220
    v_mul_f32 v139, v139, v220
    v_mfma_f32_16x16x32_bf16 v[148:151], a[232:235], a[52:55], v[148:151]
    v_cvt_pk_bf16_f32 v100, v136, v137
    v_cvt_pk_bf16_f32 v101, v138, v139
    s_waitcnt lgkmcnt(8)
    v_mfma_f32_16x16x32_bf16 v[144:147], a[236:239], a[72:75], v[144:147]
    v_mul_f32 v140, v140, v221
    v_mul_f32 v141, v141, v221
    v_mfma_f32_16x16x32_bf16 v[148:151], a[236:239], a[76:79], v[148:151]
    v_mul_f32 v142, v142, v221
    v_mul_f32 v143, v143, v221
    s_waitcnt lgkmcnt(6)
    v_mfma_f32_16x16x32_bf16 v[144:147], a[240:243], a[96:99], v[144:147]
    v_cvt_pk_bf16_f32 v102, v140, v141
    v_cvt_pk_bf16_f32 v103, v142, v143
    v_mfma_f32_16x16x32_bf16 v[148:151], a[240:243], a[100:103], v[148:151]
    buffer_store_dwordx4 v[100:103], v242, s[24:27], s43 offen sc1
    s_waitcnt lgkmcnt(4)
    v_mfma_f32_16x16x32_bf16 v[144:147], a[244:247], a[120:123], v[144:147]
    v_mfma_f32_16x16x32_bf16 v[148:151], a[244:247], a[124:127], v[148:151]
    s_waitcnt lgkmcnt(2)
    v_mfma_f32_16x16x32_bf16 v[144:147], a[248:251], a[144:147], v[144:147]
    v_mfma_f32_16x16x32_bf16 v[148:151], a[248:251], a[148:151], v[148:151]
    s_waitcnt lgkmcnt(0)
    v_mfma_f32_16x16x32_bf16 v[144:147], a[252:255], a[168:171], v[144:147]
    v_mfma_f32_16x16x32_bf16 v[148:151], a[252:255], a[172:175], v[148:151]
    v_mfma_f32_16x16x32_bf16 v[152:155], a[224:227], a[8:11], 0
    v_mfma_f32_16x16x32_bf16 v[156:159], a[224:227], a[12:15], 0
    v_mfma_f32_16x16x32_bf16 v[152:155], a[228:231], a[32:35], v[152:155]
    v_mfma_f32_16x16x32_bf16 v[156:159], a[228:231], a[36:39], v[156:159]
    s_mul_i32 s43, s48, 12288
    s_add_u32 s43, s43, s57
    v_mfma_f32_16x16x32_bf16 v[152:155], a[232:235], a[56:59], v[152:155]
    s_add_u32 s48, s48, 1
    s_cmp_eq_u32 s48, 7
    s_cselect_b32 s48, 0, s48
    v_mfma_f32_16x16x32_bf16 v[156:159], a[232:235], a[60:63], v[156:159]
    s_waitcnt vmcnt(13)
    s_barrier
    v_mfma_f32_16x16x32_bf16 v[152:155], a[236:239], a[80:83], v[152:155]
    v_mul_f32 v144, v144, v216
    v_mul_f32 v145, v145, v216
    v_mfma_f32_16x16x32_bf16 v[156:159], a[236:239], a[84:87], v[156:159]
    ds_read_b64_tr_b16 a[192:193], v27 offset:0
    v_mul_f32 v146, v146, v216
    v_mfma_f32_16x16x32_bf16 v[152:155], a[240:243], a[104:107], v[152:155]
    v_mul_f32 v147, v147, v216
    v_cvt_pk_bf16_f32 v80, v144, v145
    v_mfma_f32_16x16x32_bf16 v[156:159], a[240:243], a[108:111], v[156:159]
    ds_read_b64_tr_b16 a[194:195], v27 offset:2048
    v_cvt_pk_bf16_f32 v81, v146, v147
    v_mfma_f32_16x16x32_bf16 v[152:155], a[244:247], a[128:131], v[152:155]
    v_mul_f32 v148, v148, v217
    ds_read_b64_tr_b16 a[196:197], v27 offset:4096
    v_mfma_f32_16x16x32_bf16 v[156:159], a[244:247], a[132:135], v[156:159]
    v_mul_f32 v149, v149, v217
    v_mul_f32 v150, v150, v217
    v_mfma_f32_16x16x32_bf16 v[152:155], a[248:251], a[152:155], v[152:155]
    ds_read_b64_tr_b16 a[198:199], v27 offset:6144
    v_mul_f32 v151, v151, v217
    v_mfma_f32_16x16x32_bf16 v[156:159], a[248:251], a[156:159], v[156:159]
    v_cvt_pk_bf16_f32 v82, v148, v149
    v_cvt_pk_bf16_f32 v83, v150, v151
    buffer_store_dwordx4 v[80:83], v240, s[24:27], s43 offen sc1
    v_mfma_f32_16x16x32_bf16 v[152:155], a[252:255], a[176:179], v[152:155]
    ds_read_b64_tr_b16 a[200:201], v27 offset:8192
    ds_read_b64_tr_b16 a[202:203], v27 offset:10240
    v_mfma_f32_16x16x32_bf16 v[156:159], a[252:255], a[180:183], v[156:159]
    ds_read_b64_tr_b16 a[204:205], v27 offset:12288
    ds_read_b64_tr_b16 a[206:207], v27 offset:14336
    v_mfma_f32_16x16x32_bf16 v[160:163], a[224:227], a[16:19], 0
    ds_read_b64_tr_b16 a[208:209], v27 offset:16384
    ds_read_b64_tr_b16 a[210:211], v27 offset:18432
    v_mfma_f32_16x16x32_bf16 v[164:167], a[224:227], a[20:23], 0
    ds_read_b64_tr_b16 a[212:213], v27 offset:20480
    ds_read_b64_tr_b16 a[214:215], v27 offset:22528
    v_mfma_f32_16x16x32_bf16 v[160:163], a[228:231], a[40:43], v[160:163]
    ds_read_b64_tr_b16 a[216:217], v27 offset:24576
    v_mfma_f32_16x16x32_bf16 v[164:167], a[228:231], a[44:47], v[164:167]
    v_mul_f32 v152, v152, v218
    v_mul_f32 v153, v153, v218
    v_mfma_f32_16x16x32_bf16 v[160:163], a[232:235], a[64:67], v[160:163]
    v_mul_f32 v154, v154, v218
    v_mul_f32 v155, v155, v218
    v_mfma_f32_16x16x32_bf16 v[164:167], a[232:235], a[68:71], v[164:167]
    v_cvt_pk_bf16_f32 v84, v152, v153
    v_cvt_pk_bf16_f32 v85, v154, v155
    v_mfma_f32_16x16x32_bf16 v[160:163], a[236:239], a[88:91], v[160:163]
    v_mul_f32 v156, v156, v219
    ds_read_b64_tr_b16 a[218:219], v27 offset:26624
    v_mfma_f32_16x16x32_bf16 v[164:167], a[236:239], a[92:95], v[164:167]
    v_mul_f32 v157, v157, v219
    ds_read_b64_tr_b16 a[220:221], v27 offset:28672
    v_mfma_f32_16x16x32_bf16 v[160:163], a[240:243], a[112:115], v[160:163]
    v_mul_f32 v158, v158, v219
    v_mul_f32 v159, v159, v219
    v_mfma_f32_16x16x32_bf16 v[164:167], a[240:243], a[116:119], v[164:167]
    ds_read_b64_tr_b16 a[222:223], v27 offset:30720
    v_cvt_pk_bf16_f32 v86, v156, v157
    v_mfma_f32_16x16x32_bf16 v[160:163], a[244:247], a[136:139], v[160:163]
    v_cvt_pk_bf16_f32 v87, v158, v159
    v_mfma_f32_16x16x32_bf16 v[164:167], a[244:247], a[140:143], v[164:167]
    buffer_store_dwordx4 v[84:87], v241, s[24:27], s43 offen sc1
    v_mfma_f32_16x16x32_bf16 v[160:163], a[248:251], a[160:163], v[160:163]
    v_mfma_f32_16x16x32_bf16 v[164:167], a[248:251], a[164:167], v[164:167]
    v_mfma_f32_16x16x32_bf16 v[160:163], a[252:255], a[184:187], v[160:163]
    v_mfma_f32_16x16x32_bf16 v[164:167], a[252:255], a[188:191], v[164:167]
    s_waitcnt lgkmcnt(14)
    v_mfma_f32_16x16x32_bf16 v[32:35], a[192:195], a[0:3], 0
    v_mfma_f32_16x16x32_bf16 v[36:39], a[192:195], a[4:7], 0
    s_waitcnt lgkmcnt(12)
    v_mfma_f32_16x16x32_bf16 v[32:35], a[196:199], a[24:27], v[32:35]
    v_mfma_f32_16x16x32_bf16 v[36:39], a[196:199], a[28:31], v[36:39]
    s_nop 0
    v_mul_f32 v160, v160, v220
    v_mul_f32 v161, v161, v220
    s_waitcnt lgkmcnt(10)
    v_mfma_f32_16x16x32_bf16 v[32:35], a[200:203], a[48:51], v[32:35]
    v_mul_f32 v162, v162, v220
    v_mul_f32 v163, v163, v220
    v_mfma_f32_16x16x32_bf16 v[36:39], a[200:203], a[52:55], v[36:39]
    v_cvt_pk_bf16_f32 v88, v160, v161
    v_cvt_pk_bf16_f32 v89, v162, v163
    s_waitcnt lgkmcnt(8)
    v_mfma_f32_16x16x32_bf16 v[32:35], a[204:207], a[72:75], v[32:35]
    v_mul_f32 v164, v164, v221
    v_mul_f32 v165, v165, v221
    v_mfma_f32_16x16x32_bf16 v[36:39], a[204:207], a[76:79], v[36:39]
    v_mul_f32 v166, v166, v221
    v_mul_f32 v167, v167, v221
    s_waitcnt lgkmcnt(6)
    v_mfma_f32_16x16x32_bf16 v[32:35], a[208:211], a[96:99], v[32:35]
    v_cvt_pk_bf16_f32 v90, v164, v165
    v_cvt_pk_bf16_f32 v91, v166, v167
    v_mfma_f32_16x16x32_bf16 v[36:39], a[208:211], a[100:103], v[36:39]
    buffer_store_dwordx4 v[88:91], v242, s[24:27], s43 offen sc1
    s_waitcnt lgkmcnt(4)
    v_mfma_f32_16x16x32_bf16 v[32:35], a[212:215], a[120:123], v[32:35]
    v_mfma_f32_16x16x32_bf16 v[36:39], a[212:215], a[124:127], v[36:39]
    s_waitcnt lgkmcnt(2)
    v_mfma_f32_16x16x32_bf16 v[32:35], a[216:219], a[144:147], v[32:35]
    v_mfma_f32_16x16x32_bf16 v[36:39], a[216:219], a[148:151], v[36:39]
    s_waitcnt lgkmcnt(0)
    v_mfma_f32_16x16x32_bf16 v[32:35], a[220:223], a[168:171], v[32:35]
    v_mfma_f32_16x16x32_bf16 v[36:39], a[220:223], a[172:175], v[36:39]
    v_mfma_f32_16x16x32_bf16 v[40:43], a[192:195], a[8:11], 0
    v_mfma_f32_16x16x32_bf16 v[44:47], a[192:195], a[12:15], 0
    v_mfma_f32_16x16x32_bf16 v[40:43], a[196:199], a[32:35], v[40:43]
    v_mfma_f32_16x16x32_bf16 v[44:47], a[196:199], a[36:39], v[44:47]
    s_mul_i32 s43, s48, 12288
    s_add_u32 s43, s43, s57
    v_mfma_f32_16x16x32_bf16 v[40:43], a[200:203], a[56:59], v[40:43]
    s_add_u32 s48, s48, 1
    s_cmp_eq_u32 s48, 7
    s_cselect_b32 s48, 0, s48
    v_mfma_f32_16x16x32_bf16 v[44:47], a[200:203], a[60:63], v[44:47]
    s_waitcnt vmcnt(3)
    s_barrier
    v_mfma_f32_16x16x32_bf16 v[40:43], a[204:207], a[80:83], v[40:43]
    v_mul_f32 v32, v32, v216
    v_mul_f32 v33, v33, v216
    v_mfma_f32_16x16x32_bf16 v[44:47], a[204:207], a[84:87], v[44:47]
    buffer_store_dword v252, v244, s[24:27], s35 offen sc1
    v_mfma_f32_16x16x32_bf16 v[40:43], a[208:211], a[104:107], v[40:43]
    v_mul_f32 v34, v34, v216
    v_mul_f32 v35, v35, v216
    v_mfma_f32_16x16x32_bf16 v[44:47], a[208:211], a[108:111], v[44:47]
    v_cvt_pk_bf16_f32 v92, v32, v33
    ds_read_b64_tr_b16 a[224:225], v26 offset:0
    v_mfma_f32_16x16x32_bf16 v[40:43], a[212:215], a[128:131], v[40:43]
    v_cvt_pk_bf16_f32 v93, v34, v35
    v_mul_f32 v36, v36, v217
    v_mfma_f32_16x16x32_bf16 v[44:47], a[212:215], a[132:135], v[44:47]
    ds_read_b64_tr_b16 a[226:227], v26 offset:2048
    v_mul_f32 v37, v37, v217
    v_mfma_f32_16x16x32_bf16 v[40:43], a[216:219], a[152:155], v[40:43]
    v_mul_f32 v38, v38, v217
    ds_read_b64_tr_b16 a[228:229], v26 offset:4096
    v_mfma_f32_16x16x32_bf16 v[44:47], a[216:219], a[156:159], v[44:47]
    v_mul_f32 v39, v39, v217
    v_cvt_pk_bf16_f32 v94, v36, v37
    v_cvt_pk_bf16_f32 v95, v38, v39
    buffer_store_dwordx4 v[92:95], v240, s[24:27], s43 offen sc1
    v_mfma_f32_16x16x32_bf16 v[40:43], a[220:223], a[176:179], v[40:43]
    ds_read_b64_tr_b16 a[230:231], v26 offset:6144
    ds_read_b64_tr_b16 a[232:233], v26 offset:8192
    v_mfma_f32_16x16x32_bf16 v[44:47], a[220:223], a[180:183], v[44:47]
    ds_read_b64_tr_b16 a[234:235], v26 offset:10240
    ds_read_b64_tr_b16 a[236:237], v26 offset:12288
    v_mfma_f32_16x16x32_bf16 v[48:51], a[192:195], a[16:19], 0
    ds_read_b64_tr_b16 a[238:239], v26 offset:14336
    ds_read_b64_tr_b16 a[240:241], v26 offset:16384
    v_mfma_f32_16x16x32_bf16 v[52:55], a[192:195], a[20:23], 0
    ds_read_b64_tr_b16 a[242:243], v26 offset:18432
    ds_read_b64_tr_b16 a[244:245], v26 offset:20480
    v_mfma_f32_16x16x32_bf16 v[48:51], a[196:199], a[40:43], v[48:51]
    ds_read_b64_tr_b16 a[246:247], v26 offset:22528
    ds_read_b64_tr_b16 a[248:249], v26 offset:24576
    v_mfma_f32_16x16x32_bf16 v[52:55], a[196:199], a[44:47], v[52:55]
    v_mul_f32 v40, v40, v218
    v_mul_f32 v41, v41, v218
    v_mfma_f32_16x16x32_bf16 v[48:51], a[200:203], a[64:67], v[48:51]
    v_mul_f32 v42, v42, v218
    v_mul_f32 v43, v43, v218
    v_mfma_f32_16x16x32_bf16 v[52:55], a[200:203], a[68:71], v[52:55]
    v_cvt_pk_bf16_f32 v96, v40, v41
    v_cvt_pk_bf16_f32 v97, v42, v43
    v_mfma_f32_16x16x32_bf16 v[48:51], a[204:207], a[88:91], v[48:51]
    v_mul_f32 v44, v44, v219
    ds_read_b64_tr_b16 a[250:251], v26 offset:26624
    v_mfma_f32_16x16x32_bf16 v[52:55], a[204:207], a[92:95], v[52:55]
    v_mul_f32 v45, v45, v219
    v_mul_f32 v46, v46, v219
    v_mfma_f32_16x16x32_bf16 v[48:51], a[208:211], a[112:115], v[48:51]
    ds_read_b64_tr_b16 a[252:253], v26 offset:28672
    v_mul_f32 v47, v47, v219
    v_mfma_f32_16x16x32_bf16 v[52:55], a[208:211], a[116:119], v[52:55]
    ds_read_b64_tr_b16 a[254:255], v26 offset:30720
    v_cvt_pk_bf16_f32 v98, v44, v45
    v_mfma_f32_16x16x32_bf16 v[48:51], a[212:215], a[136:139], v[48:51]
    v_cvt_pk_bf16_f32 v99, v46, v47
    v_mfma_f32_16x16x32_bf16 v[52:55], a[212:215], a[140:143], v[52:55]
    buffer_store_dwordx4 v[96:99], v241, s[24:27], s43 offen sc1
    v_mfma_f32_16x16x32_bf16 v[48:51], a[216:219], a[160:163], v[48:51]
    v_mfma_f32_16x16x32_bf16 v[52:55], a[216:219], a[164:167], v[52:55]
    v_mfma_f32_16x16x32_bf16 v[48:51], a[220:223], a[184:187], v[48:51]
    v_mfma_f32_16x16x32_bf16 v[52:55], a[220:223], a[188:191], v[52:55]
    s_waitcnt lgkmcnt(14)
    v_mfma_f32_16x16x32_bf16 v[120:123], a[224:227], a[0:3], 0
    v_mfma_f32_16x16x32_bf16 v[124:127], a[224:227], a[4:7], 0
    s_waitcnt lgkmcnt(12)
    v_mfma_f32_16x16x32_bf16 v[120:123], a[228:231], a[24:27], v[120:123]
    v_mfma_f32_16x16x32_bf16 v[124:127], a[228:231], a[28:31], v[124:127]
    s_nop 0
    v_mul_f32 v48, v48, v220
    v_mul_f32 v49, v49, v220
    s_waitcnt lgkmcnt(10)
    v_mfma_f32_16x16x32_bf16 v[120:123], a[232:235], a[48:51], v[120:123]
    v_mul_f32 v50, v50, v220
    v_mul_f32 v51, v51, v220
    v_mfma_f32_16x16x32_bf16 v[124:127], a[232:235], a[52:55], v[124:127]
    v_cvt_pk_bf16_f32 v100, v48, v49
    v_cvt_pk_bf16_f32 v101, v50, v51
    s_waitcnt lgkmcnt(8)
    v_mfma_f32_16x16x32_bf16 v[120:123], a[236:239], a[72:75], v[120:123]
    v_mul_f32 v52, v52, v221
    v_mul_f32 v53, v53, v221
    v_mfma_f32_16x16x32_bf16 v[124:127], a[236:239], a[76:79], v[124:127]
    v_mul_f32 v54, v54, v221
    v_mul_f32 v55, v55, v221
    s_waitcnt lgkmcnt(6)
    v_mfma_f32_16x16x32_bf16 v[120:123], a[240:243], a[96:99], v[120:123]
    v_cvt_pk_bf16_f32 v102, v52, v53
    v_cvt_pk_bf16_f32 v103, v54, v55
    v_mfma_f32_16x16x32_bf16 v[124:127], a[240:243], a[100:103], v[124:127]
    buffer_store_dwordx4 v[100:103], v242, s[24:27], s43 offen sc1
    s_waitcnt lgkmcnt(4)
    v_mfma_f32_16x16x32_bf16 v[120:123], a[244:247], a[120:123], v[120:123]
    v_mfma_f32_16x16x32_bf16 v[124:127], a[244:247], a[124:127], v[124:127]
    s_waitcnt lgkmcnt(2)
    v_mfma_f32_16x16x32_bf16 v[120:123], a[248:251], a[144:147], v[120:123]
    v_mfma_f32_16x16x32_bf16 v[124:127], a[248:251], a[148:151], v[124:127]
    s_waitcnt lgkmcnt(0)
    v_mfma_f32_16x16x32_bf16 v[120:123], a[252:255], a[168:171], v[120:123]
    v_mfma_f32_16x16x32_bf16 v[124:127], a[252:255], a[172:175], v[124:127]
    v_mfma_f32_16x16x32_bf16 v[128:131], a[224:227], a[8:11], 0
    v_mfma_f32_16x16x32_bf16 v[132:135], a[224:227], a[12:15], 0
    v_mfma_f32_16x16x32_bf16 v[128:131], a[228:231], a[32:35], v[128:131]
    v_mfma_f32_16x16x32_bf16 v[132:135], a[228:231], a[36:39], v[132:135]
    s_mul_i32 s43, s48, 12288
    s_add_u32 s43, s43, s57
    v_mfma_f32_16x16x32_bf16 v[128:131], a[232:235], a[56:59], v[128:131]
    s_add_u32 s48, s48, 1
    s_cmp_eq_u32 s48, 7
    s_cselect_b32 s48, 0, s48
    v_mfma_f32_16x16x32_bf16 v[132:135], a[232:235], a[60:63], v[132:135]
    v_mul_f32 v120, v120, v216
    v_mul_f32 v121, v121, v216
    v_mfma_f32_16x16x32_bf16 v[128:131], a[236:239], a[80:83], v[128:131]
    v_mul_f32 v122, v122, v216
    v_mul_f32 v123, v123, v216
    v_mfma_f32_16x16x32_bf16 v[132:135], a[236:239], a[84:87], v[132:135]
    v_cvt_pk_bf16_f32 v80, v120, v121
    v_cvt_pk_bf16_f32 v81, v122, v123
    v_mfma_f32_16x16x32_bf16 v[128:131], a[240:243], a[104:107], v[128:131]
    v_mul_f32 v124, v124, v217
    v_mul_f32 v125, v125, v217
    v_mfma_f32_16x16x32_bf16 v[132:135], a[240:243], a[108:111], v[132:135]
    v_mul_f32 v126, v126, v217
    v_mul_f32 v127, v127, v217
    v_mfma_f32_16x16x32_bf16 v[128:131], a[244:247], a[128:131], v[128:131]
    v_cvt_pk_bf16_f32 v82, v124, v125
    v_cvt_pk_bf16_f32 v83, v126, v127
    v_mfma_f32_16x16x32_bf16 v[132:135], a[244:247], a[132:135], v[132:135]
    buffer_store_dwordx4 v[80:83], v240, s[24:27], s43 offen sc1
    v_mfma_f32_16x16x32_bf16 v[128:131], a[248:251], a[152:155], v[128:131]
    v_mfma_f32_16x16x32_bf16 v[132:135], a[248:251], a[156:159], v[132:135]
    v_mfma_f32_16x16x32_bf16 v[128:131], a[252:255], a[176:179], v[128:131]
    v_mfma_f32_16x16x32_bf16 v[132:135], a[252:255], a[180:183], v[132:135]
    v_mfma_f32_16x16x32_bf16 v[136:139], a[224:227], a[16:19], 0
    v_mfma_f32_16x16x32_bf16 v[140:143], a[224:227], a[20:23], 0
    v_mfma_f32_16x16x32_bf16 v[136:139], a[228:231], a[40:43], v[136:139]
    v_mfma_f32_16x16x32_bf16 v[140:143], a[228:231], a[44:47], v[140:143]
    s_nop 2
    v_mul_f32 v128, v128, v218
    v_mul_f32 v129, v129, v218
    v_mfma_f32_16x16x32_bf16 v[136:139], a[232:235], a[64:67], v[136:139]
    v_mul_f32 v130, v130, v218
    v_mul_f32 v131, v131, v218
    v_mfma_f32_16x16x32_bf16 v[140:143], a[232:235], a[68:71], v[140:143]
    v_cvt_pk_bf16_f32 v84, v128, v129
    v_cvt_pk_bf16_f32 v85, v130, v131
    v_mfma_f32_16x16x32_bf16 v[136:139], a[236:239], a[88:91], v[136:139]
    v_mul_f32 v132, v132, v219
    v_mul_f32 v133, v133, v219
    v_mfma_f32_16x16x32_bf16 v[140:143], a[236:239], a[92:95], v[140:143]
    v_mul_f32 v134, v134, v219
    v_mul_f32 v135, v135, v219
    v_mfma_f32_16x16x32_bf16 v[136:139], a[240:243], a[112:115], v[136:139]
    v_cvt_pk_bf16_f32 v86, v132, v133
    v_cvt_pk_bf16_f32 v87, v134, v135
    v_mfma_f32_16x16x32_bf16 v[140:143], a[240:243], a[116:119], v[140:143]
    buffer_store_dwordx4 v[84:87], v241, s[24:27], s43 offen sc1
    v_mfma_f32_16x16x32_bf16 v[136:139], a[244:247], a[136:139], v[136:139]
    v_mfma_f32_16x16x32_bf16 v[140:143], a[244:247], a[140:143], v[140:143]
    v_mfma_f32_16x16x32_bf16 v[136:139], a[248:251], a[160:163], v[136:139]
    v_mfma_f32_16x16x32_bf16 v[140:143], a[248:251], a[164:167], v[140:143]
    v_mfma_f32_16x16x32_bf16 v[136:139], a[252:255], a[184:187], v[136:139]
    v_mfma_f32_16x16x32_bf16 v[140:143], a[252:255], a[188:191], v[140:143]
    s_nop 6
    v_mul_f32 v136, v136, v220
    v_mul_f32 v137, v137, v220
    v_mul_f32 v138, v138, v220
    v_mul_f32 v139, v139, v220
    v_cvt_pk_bf16_f32 v88, v136, v137
    v_cvt_pk_bf16_f32 v89, v138, v139
    v_mul_f32 v140, v140, v221
    v_mul_f32 v141, v141, v221
    v_mul_f32 v142, v142, v221
    v_mul_f32 v143, v143, v221
    v_cvt_pk_bf16_f32 v90, v140, v141
    v_cvt_pk_bf16_f32 v91, v142, v143
    buffer_store_dwordx4 v[88:91], v242, s[24:27], s43 offen sc1
    s_cmp_eq_u32 s28, 3
    s_cbranch_scc1 L_w3
    v_lshrrev_b32 v252, 4, v1
    v_and_b32 v253, 15, v1
    v_mul_u32_u24 v246, 86272, v252
    v_lshl_add_u32 v246, v253, 4, v246
    v_add_u32 v255, 345088, v246
    v_and_b32 v247, 3, v1
    s_mul_i32 s46, s30, 3
    s_add_u32 s46, s46, s28
    s_mul_i32 s52, s29, 1380352
    s_lshl_b32 s43, s46, 8
    s_add_u32 s52, s52, s43
    s_mul_i32 s59, s29, 86016
    s_lshr_b32 s43, s46, 4
    s_mul_i32 s43, s43, 28672
    s_add_u32 s59, s59, s43
    s_bfe_u32 s43, s46, 0x20002
    s_mul_i32 s43, s43, 3584
    s_add_u32 s59, s59, s43
    s_and_b32 s43, s46, 3
    s_lshl_b32 s43, s43, 5
    s_add_u32 s59, s59, s43
    s_mov_b32 s46, s44
    s_waitcnt vmcnt(0)
    s_barrier
    v_lshl_add_u32 v247, v252, 4, v247
    v_mul_u32_u24 v247, 896, v247
    v_bfe_u32 v252, v1, 2, 2
    v_lshl_add_u32 v247, v252, 3, v247
    v_lshrrev_b32 v252, 5, v1
    v_lshl_add_u32 v247, v252, 30, v247
    v_lshlrev_b32 v253, 4, v253
    v_mov_b32 v248, 0x3f80
    v_mov_b32 v249, 0
    v_lshlrev_b64 v[248:249], v253, v[248:249]
    v_bfe_u32 v252, v1, 2, 2
    v_cmp_eq_u32 vcc, 1, v252
    s_nop 1
    v_cndmask_b32 v250, 0, v248, vcc
    v_cndmask_b32 v251, 0, v249, vcc
    v_cmp_eq_u32 vcc, 0, v252
    s_nop 1
    v_cndmask_b32 v248, 0, v248, vcc
    v_cndmask_b32 v249, 0, v249, vcc
    v_add_u32 v2, 690176, v246
    v_add_u32 v3, 1035264, v246
    s_mul_i32 s60, s46, 12288
    s_add_u32 s60, s60, s52
    s_lshl_b32 s40, s46, 7
    s_add_u32 s40, s40, s59
    s_add_u32 s46, s46, 1
    s_cmp_eq_u32 s46, 7
    s_cselect_b32 s46, 0, s46
    s_mul_i32 s61, s46, 12288
    s_add_u32 s61, s61, s52
    s_lshl_b32 s41, s46, 7
    s_add_u32 s41, s41, s59
    s_add_u32 s46, s46, 1
    s_cmp_eq_u32 s46, 7
    s_cselect_b32 s46, 0, s46
    s_mul_i32 s62, s46, 12288
    s_add_u32 s62, s62, s52
    s_lshl_b32 s54, s46, 7
    s_add_u32 s54, s54, s59
    s_add_u32 s46, s46, 1
    s_cmp_eq_u32 s46, 7
    s_cselect_b32 s46, 0, s46
    s_mul_i32 s63, s46, 12288
    s_add_u32 s63, s63, s52
    s_lshl_b32 s55, s46, 7
    s_add_u32 s55, s55, s59
    s_add_u32 s46, s46, 1
    s_cmp_eq_u32 s46, 7
    s_cselect_b32 s46, 0, s46
    s_mul_i32 s64, s46, 12288
    s_add_u32 s64, s64, s52
    s_lshl_b32 s58, s46, 7
    s_add_u32 s58, s58, s59
    s_add_u32 s46, s46, 1
    s_cmp_eq_u32 s46, 7
    s_cselect_b32 s46, 0, s46
    s_mul_i32 s65, s46, 12288
    s_add_u32 s65, s65, s52
    s_lshl_b32 s49, s46, 7
    s_add_u32 s49, s49, s59
    s_add_u32 s46, s46, 1
    s_cmp_eq_u32 s46, 7
    s_cselect_b32 s46, 0, s46
    s_mul_i32 s66, s46, 12288
    s_add_u32 s66, s66, s52
    s_lshl_b32 s31, s46, 7
    s_add_u32 s31, s31, s59
    s_add_u32 s46, s46, 1
    s_cmp_eq_u32 s46, 7
    s_cselect_b32 s46, 0, s46
    s_barrier
    buffer_load_dwordx4 v[104:107], v246, s[24:27], s60 offen sc1
    buffer_load_dwordx4 v[108:111], v255, s[24:27], s60 offen sc1
    buffer_load_dwordx4 v[112:115], v2, s[24:27], s60 offen sc1
    buffer_load_dwordx4 v[116:119], v3, s[24:27], s60 offen sc1
    buffer_load_dwordx4 v[120:123], v246, s[24:27], s61 offen sc1
    buffer_load_dwordx4 v[124:127], v255, s[24:27], s61 offen sc1
    buffer_load_dwordx4 v[128:131], v2, s[24:27], s61 offen sc1
    buffer_load_dwordx4 v[132:135], v3, s[24:27], s61 offen sc1
    buffer_load_dwordx4 v[136:139], v246, s[24:27], s62 offen sc1
    buffer_load_dwordx4 v[140:143], v255, s[24:27], s62 offen sc1
    buffer_load_dwordx4 v[144:147], v2, s[24:27], s62 offen sc1
    buffer_load_dwordx4 v[148:151], v3, s[24:27], s62 offen sc1
    buffer_load_dwordx4 v[152:155], v246, s[24:27], s63 offen sc1
    buffer_load_dwordx4 v[156:159], v255, s[24:27], s63 offen sc1
    buffer_load_dwordx4 v[160:163], v2, s[24:27], s63 offen sc1
    buffer_load_dwordx4 v[164:167], v3, s[24:27], s63 offen sc1
    s_barrier
    buffer_load_dwordx4 v[168:171], v246, s[24:27], s64 offen sc1
    buffer_load_dwordx4 v[172:175], v255, s[24:27], s64 offen sc1
    buffer_load_dwordx4 v[176:179], v2, s[24:27], s64 offen sc1
    buffer_load_dwordx4 v[180:183], v3, s[24:27], s64 offen sc1
    buffer_load_dwordx4 v[184:187], v246, s[24:27], s65 offen sc1
    buffer_load_dwordx4 v[188:191], v255, s[24:27], s65 offen sc1
    buffer_load_dwordx4 v[192:195], v2, s[24:27], s65 offen sc1
    buffer_load_dwordx4 v[196:199], v3, s[24:27], s65 offen sc1
    buffer_load_dwordx4 v[200:203], v246, s[24:27], s66 offen sc1
    buffer_load_dwordx4 v[204:207], v255, s[24:27], s66 offen sc1
    buffer_load_dwordx4 v[208:211], v2, s[24:27], s66 offen sc1
    buffer_load_dwordx4 v[212:215], v3, s[24:27], s66 offen sc1
    s_waitcnt vmcnt(27)
    v_mfma_f32_16x16x32_bf16 v[32:35], v[248:251], v[104:107], 0
    s_waitcnt vmcnt(26)
    v_mfma_f32_16x16x32_bf16 v[32:35], v[248:251], v[108:111], v[32:35]
    s_waitcnt vmcnt(25)
    v_mfma_f32_16x16x32_bf16 v[32:35], v[248:251], v[112:115], v[32:35]
    s_waitcnt vmcnt(24)
    v_mfma_f32_16x16x32_bf16 v[32:35], v[248:251], v[116:119], v[32:35]
    s_waitcnt vmcnt(23)
    v_mfma_f32_16x16x32_bf16 v[36:39], v[248:251], v[120:123], 0
    s_waitcnt vmcnt(22)
    v_mfma_f32_16x16x32_bf16 v[36:39], v[248:251], v[124:127], v[36:39]
    s_waitcnt vmcnt(21)
    v_mfma_f32_16x16x32_bf16 v[36:39], v[248:251], v[128:131], v[36:39]
    s_waitcnt vmcnt(20)
    v_mfma_f32_16x16x32_bf16 v[36:39], v[248:251], v[132:135], v[36:39]
    s_waitcnt vmcnt(19)
    v_mfma_f32_16x16x32_bf16 v[40:43], v[248:251], v[136:139], 0
    s_waitcnt vmcnt(18)
    v_mfma_f32_16x16x32_bf16 v[40:43], v[248:251], v[140:143], v[40:43]
    v_cvt_pk_bf16_f32 v32, v32, v33
    v_cvt_pk_bf16_f32 v33, v34, v35
    s_waitcnt vmcnt(17)
    v_mfma_f32_16x16x32_bf16 v[40:43], v[248:251], v[144:147], v[40:43]
    buffer_store_dwordx2 v[32:33], v247, s[84:87], s40 offen
    s_waitcnt vmcnt(17)
    v_mfma_f32_16x16x32_bf16 v[40:43], v[248:251], v[148:151], v[40:43]
    s_waitcnt vmcnt(16)
    v_mfma_f32_16x16x32_bf16 v[44:47], v[248:251], v[152:155], 0
    s_waitcnt vmcnt(15)
    v_mfma_f32_16x16x32_bf16 v[44:47], v[248:251], v[156:159], v[44:47]
    v_cvt_pk_bf16_f32 v36, v36, v37
    v_cvt_pk_bf16_f32 v37, v38, v39
    s_waitcnt vmcnt(14)
    v_mfma_f32_16x16x32_bf16 v[44:47], v[248:251], v[160:163], v[44:47]
    buffer_store_dwordx2 v[36:37], v247, s[84:87], s41 offen
    s_waitcnt vmcnt(14)
    v_mfma_f32_16x16x32_bf16 v[44:47], v[248:251], v[164:167], v[44:47]
    s_waitcnt vmcnt(13)
    v_mfma_f32_16x16x32_bf16 v[48:51], v[248:251], v[168:171], 0
    s_waitcnt vmcnt(12)
    v_mfma_f32_16x16x32_bf16 v[48:51], v[248:251], v[172:175], v[48:51]
    v_cvt_pk_bf16_f32 v40, v40, v41
    v_cvt_pk_bf16_f32 v41, v42, v43
    s_waitcnt vmcnt(11)
    v_mfma_f32_16x16x32_bf16 v[48:51], v[248:251], v[176:179], v[48:51]
    buffer_store_dwordx2 v[40:41], v247, s[84:87], s54 offen
    s_waitcnt vmcnt(11)
    v_mfma_f32_16x16x32_bf16 v[48:51], v[248:251], v[180:183], v[48:51]
    s_waitcnt vmcnt(10)
    v_mfma_f32_16x16x32_bf16 v[52:55], v[248:251], v[184:187], 0
    s_waitcnt vmcnt(9)
    v_mfma_f32_16x16x32_bf16 v[52:55], v[248:251], v[188:191], v[52:55]
    v_cvt_pk_bf16_f32 v44, v44, v45
    v_cvt_pk_bf16_f32 v45, v46, v47
    s_waitcnt vmcnt(8)
    v_mfma_f32_16x16x32_bf16 v[52:55], v[248:251], v[192:195], v[52:55]
    buffer_store_dwordx2 v[44:45], v247, s[84:87], s55 offen
    s_waitcnt vmcnt(8)
    v_mfma_f32_16x16x32_bf16 v[52:55], v[248:251], v[196:199], v[52:55]
    s_waitcnt vmcnt(7)
    v_mfma_f32_16x16x32_bf16 v[56:59], v[248:251], v[200:203], 0
    s_waitcnt vmcnt(6)
    v_mfma_f32_16x16x32_bf16 v[56:59], v[248:251], v[204:207], v[56:59]
    v_cvt_pk_bf16_f32 v48, v48, v49
    v_cvt_pk_bf16_f32 v49, v50, v51
    buffer_store_dwordx2 v[48:49], v247, s[84:87], s58 offen
    s_waitcnt vmcnt(6)
    v_mfma_f32_16x16x32_bf16 v[56:59], v[248:251], v[208:211], v[56:59]
    s_waitcnt vmcnt(5)
    v_mfma_f32_16x16x32_bf16 v[56:59], v[248:251], v[212:215], v[56:59]
    v_cvt_pk_bf16_f32 v52, v52, v53
    v_cvt_pk_bf16_f32 v53, v54, v55
    buffer_store_dwordx2 v[52:53], v247, s[84:87], s49 offen
    s_nop 4
    v_cvt_pk_bf16_f32 v56, v56, v57
    v_cvt_pk_bf16_f32 v57, v58, v59
    buffer_store_dwordx2 v[56:57], v247, s[84:87], s31 offen
L_fin:
L_done:
    s_endpgm
L_sf0:
    ds_write_b32 v14, v116
    s_branch L_sb0
L_call0:
    s_call_b64 s[50:51], L_slow
    s_branch L_back0
L_sf1:
    ds_write_b32 v14, v116
    s_branch L_sb1
L_call1:
    s_call_b64 s[50:51], L_slow
    s_branch L_back1
L_sf2:
    ds_write_b32 v14, v116
    s_branch L_sb2
L_call2:
    s_call_b64 s[50:51], L_slow
    s_branch L_back2
L_sf3:
    ds_write_b32 v14, v116
    s_branch L_sb3
L_call3:
    s_call_b64 s[50:51], L_slow
    s_branch L_back3
L_sf4:
    ds_write_b32 v14, v116
    s_branch L_sb4
L_call4:
    s_call_b64 s[50:51], L_slow
    v_exp_f32 v216, v56
    v_exp_f32 v217, v57
    v_exp_f32 v218, v58
    v_exp_f32 v219, v59
    v_exp_f32 v228, v68
    v_exp_f32 v229, v69
    v_exp_f32 v230, v70
    v_exp_f32 v231, v71
    v_exp_f32 v220, v60
    v_cvt_pk_bf16_f32 v80, v216, v217
    v_cvt_pk_bf16_f32 v81, v218, v219
    v_cvt_pk_bf16_f32 v82, v228, v229
    v_cvt_pk_bf16_f32 v83, v230, v231
    ds_write_b128 v9, v[80:83] offset:12288
    v_exp_f32 v221, v61
    v_exp_f32 v222, v62
    v_exp_f32 v223, v63
    v_exp_f32 v232, v72
    v_exp_f32 v233, v73
    v_exp_f32 v234, v74
    v_exp_f32 v235, v75
    v_exp_f32 v224, v64
    v_cvt_pk_bf16_f32 v84, v220, v221
    v_cvt_pk_bf16_f32 v85, v222, v223
    v_cvt_pk_bf16_f32 v86, v232, v233
    v_cvt_pk_bf16_f32 v87, v234, v235
    ds_write_b128 v9, v[84:87] offset:13312
    v_exp_f32 v225, v65
    v_exp_f32 v226, v66
    v_exp_f32 v227, v67
    v_exp_f32 v236, v76
    v_exp_f32 v237, v77
    v_exp_f32 v238, v78
    v_exp_f32 v239, v79
    v_cvt_pk_bf16_f32 v88, v224, v225
    v_cvt_pk_bf16_f32 v89, v226, v227
    v_cvt_pk_bf16_f32 v90, v236, v237
    v_cvt_pk_bf16_f32 v91, v238, v239
    ds_write_b128 v9, v[88:91] offset:14336
    s_branch L_back4
L_notrdy:
    s_mov_b32 s46, 0
    s_lshl_b32 s3, s29, 4
L_rdyspin:
    s_sleep 8
    buffer_load_dword v245, v244, s[88:91], s3 offen sc1
    s_waitcnt vmcnt(0)
    v_readfirstlane_b32 s45, v245
    s_nop 1
    s_cmp_lg_u32 s45, 0
    s_cbranch_scc1 L_rdy
    s_add_u32 s46, s46, 1
    s_cmp_lt_u32 s46, 0x100000
    s_cbranch_scc1 L_rdyspin
    s_branch L_rdy
L_w3:
    buffer_load_dword v31, v243, s[24:27], s34 offen sc1
    s_waitcnt vmcnt(1)
    s_barrier
    buffer_store_dword v253, v244, s[24:27], s35 offen sc1
    s_waitcnt vmcnt(1)
    s_mov_b32 s46, 0
L_ps1:
    v_cmp_le_u32 vcc, 1, v31
    s_nop 1
    s_cmp_eq_u64 vcc, -1
    s_cbranch_scc1 L_pk1
    s_sleep 4
    buffer_load_dword v31, v243, s[24:27], s34 offen sc1
    s_waitcnt vmcnt(0)
    s_add_u32 s46, s46, 1
    s_cmp_lt_u32 s46, 0x200000
    s_cbranch_scc1 L_ps1
L_pk1:
    s_barrier
    s_mov_b32 s46, 0
L_ps2:
    v_cmp_le_u32 vcc, 2, v31
    s_nop 1
    s_cmp_eq_u64 vcc, -1
    s_cbranch_scc1 L_pk2
    s_sleep 4
    buffer_load_dword v31, v243, s[24:27], s34 offen sc1
    s_waitcnt vmcnt(0)
    s_add_u32 s46, s46, 1
    s_cmp_lt_u32 s46, 0x200000
    s_cbranch_scc1 L_ps2
L_pk2:
    s_barrier
    s_branch L_fin
L_slow:
    s_nop 7
    s_waitcnt lgkmcnt(0)
    v_max3_f32 v21, v56, v57, v58
    v_max3_f32 v21, v21, v59, v68
    v_max3_f32 v21, v21, v69, v70
    v_max_f32 v21, v21, v71
    v_max3_f32 v22, v60, v61, v62
    v_max3_f32 v22, v22, v63, v72
    v_max3_f32 v22, v22, v73, v74
    v_max_f32 v22, v22, v75
    v_max3_f32 v23, v64, v65, v66
    v_max3_f32 v23, v23, v67, v76
    v_max3_f32 v23, v23, v77, v78
    v_max_f32 v23, v23, v79
    ds_write_b32 v28, v21 offset:0
    ds_write_b32 v28, v22 offset:256
    ds_write_b32 v28, v23 offset:512
    s_waitcnt lgkmcnt(0)
    s_barrier
    ds_read_b128 v[80:83], v29 offset:0
    ds_read_b128 v[92:95], v30 offset:0
    ds_read_b128 v[84:87], v29 offset:256
    ds_read_b128 v[96:99], v30 offset:256
    ds_read_b128 v[88:91], v29 offset:512
    ds_read_b128 v[100:103], v30 offset:512
    v_mov_b32 v20, 0
    s_waitcnt lgkmcnt(5)
    v_max3_f32 v216, v80, v81, v82
    s_waitcnt lgkmcnt(4)
    v_max3_f32 v216, v216, v83, v92
    v_max3_f32 v216, v216, v93, v94
    v_max_f32 v216, v216, v95
    v_ceil_f32 v216, v216
    v_max_f32 v216, 0, v216
    v_add_f32 v16, v16, v216
    v_sub_f32 v56, v56, v216
    v_sub_f32 v57, v57, v216
    v_sub_f32 v58, v58, v216
    v_sub_f32 v59, v59, v216
    v_sub_f32 v68, v68, v216
    v_sub_f32 v69, v69, v216
    v_sub_f32 v70, v70, v216
    v_sub_f32 v71, v71, v216
    v_sub_f32 v216, 0, v216
    v_exp_f32 v21, v216
    s_waitcnt lgkmcnt(3)
    v_max3_f32 v217, v84, v85, v86
    s_waitcnt lgkmcnt(2)
    v_max3_f32 v217, v217, v87, v96
    v_max3_f32 v217, v217, v97, v98
    v_max_f32 v217, v217, v99
    v_ceil_f32 v217, v217
    v_max_f32 v217, 0, v217
    v_add_f32 v17, v17, v217
    v_sub_f32 v60, v60, v217
    v_sub_f32 v61, v61, v217
    v_sub_f32 v62, v62, v217
    v_sub_f32 v63, v63, v217
    v_sub_f32 v72, v72, v217
    v_sub_f32 v73, v73, v217
    v_sub_f32 v74, v74, v217
    v_sub_f32 v75, v75, v217
    v_sub_f32 v217, 0, v217
    v_exp_f32 v22, v217
    s_waitcnt lgkmcnt(1)
    v_max3_f32 v218, v88, v89, v90
    s_waitcnt lgkmcnt(0)
    v_max3_f32 v218, v218, v91, v100
    v_max3_f32 v218, v218, v101, v102
    v_max_f32 v218, v218, v103
    v_ceil_f32 v218, v218
    v_max_f32 v218, 0, v218
    v_add_f32 v18, v18, v218
    v_sub_f32 v64, v64, v218
    v_sub_f32 v65, v65, v218
    v_sub_f32 v66, v66, v218
    v_sub_f32 v67, v67, v218
    v_sub_f32 v76, v76, v218
    v_sub_f32 v77, v77, v218
    v_sub_f32 v78, v78, v218
    v_sub_f32 v79, v79, v218
    v_sub_f32 v218, 0, v218
    v_exp_f32 v23, v218
    ds_write_b32 v14, v20
    v_mul_f32 v120, v120, v21
    v_mul_f32 v121, v121, v21
    v_mul_f32 v122, v122, v21
    v_mul_f32 v123, v123, v21
    v_mul_f32 v124, v124, v22
    v_mul_f32 v125, v125, v22
    v_mul_f32 v126, v126, v22
    v_mul_f32 v127, v127, v22
    v_mul_f32 v128, v128, v23
    v_mul_f32 v129, v129, v23
    v_mul_f32 v130, v130, v23
    v_mul_f32 v131, v131, v23
    v_mul_f32 v132, v132, v21
    v_mul_f32 v133, v133, v21
    v_mul_f32 v134, v134, v21
    v_mul_f32 v135, v135, v21
    v_mul_f32 v136, v136, v22
    v_mul_f32 v137, v137, v22
    v_mul_f32 v138, v138, v22
    v_mul_f32 v139, v139, v22
    v_mul_f32 v140, v140, v23
    v_mul_f32 v141, v141, v23
    v_mul_f32 v142, v142, v23
    v_mul_f32 v143, v143, v23
    v_mul_f32 v144, v144, v21
    v_mul_f32 v145, v145, v21
    v_mul_f32 v146, v146, v21
    v_mul_f32 v147, v147, v21
    v_mul_f32 v148, v148, v22
    v_mul_f32 v149, v149, v22
    v_mul_f32 v150, v150, v22
    v_mul_f32 v151, v151, v22
    v_mul_f32 v152, v152, v23
    v_mul_f32 v153, v153, v23
    v_mul_f32 v154, v154, v23
    v_mul_f32 v155, v155, v23
    v_mul_f32 v156, v156, v21
    v_mul_f32 v157, v157, v21
    v_mul_f32 v158, v158, v21
    v_mul_f32 v159, v159, v21
    v_mul_f32 v160, v160, v22
    v_mul_f32 v161, v161, v22
    v_mul_f32 v162, v162, v22
    v_mul_f32 v163, v163, v22
    v_mul_f32 v164, v164, v23
    v_mul_f32 v165, v165, v23
    v_mul_f32 v166, v166, v23
    v_mul_f32 v167, v167, v23
    v_mul_f32 v168, v168, v21
    v_mul_f32 v169, v169, v21
    v_mul_f32 v170, v170, v21
    v_mul_f32 v171, v171, v21
    v_mul_f32 v172, v172, v22
    v_mul_f32 v173, v173, v22
    v_mul_f32 v174, v174, v22
    v_mul_f32 v175, v175, v22
    v_mul_f32 v176, v176, v23
    v_mul_f32 v177, v177, v23
    v_mul_f32 v178, v178, v23
    v_mul_f32 v179, v179, v23
    v_mul_f32 v180, v180, v21
    v_mul_f32 v181, v181, v21
    v_mul_f32 v182, v182, v21
    v_mul_f32 v183, v183, v21
    v_mul_f32 v184, v184, v22
    v_mul_f32 v185, v185, v22
    v_mul_f32 v186, v186, v22
    v_mul_f32 v187, v187, v22
    v_mul_f32 v188, v188, v23
    v_mul_f32 v189, v189, v23
    v_mul_f32 v190, v190, v23
    v_mul_f32 v191, v191, v23
    v_mul_f32 v192, v192, v21
    v_mul_f32 v193, v193, v21
    v_mul_f32 v194, v194, v21
    v_mul_f32 v195, v195, v21
    v_mul_f32 v196, v196, v22
    v_mul_f32 v197, v197, v22
    v_mul_f32 v198, v198, v22
    v_mul_f32 v199, v199, v22
    v_mul_f32 v200, v200, v23
    v_mul_f32 v201, v201, v23
    v_mul_f32 v202, v202, v23
    v_mul_f32 v203, v203, v23
    v_mul_f32 v204, v204, v21
    v_mul_f32 v205, v205, v21
    v_mul_f32 v206, v206, v21
    v_mul_f32 v207, v207, v21
    v_mul_f32 v208, v208, v22
    v_mul_f32 v209, v209, v22
    v_mul_f32 v210, v210, v22
    v_mul_f32 v211, v211, v22
    v_mul_f32 v212, v212, v23
    v_mul_f32 v213, v213, v23
    v_mul_f32 v214, v214, v23
    v_mul_f32 v215, v215, v23
    v_mul_f32 v104, v104, v21
    v_mul_f32 v105, v105, v21
    v_mul_f32 v106, v106, v21
    v_mul_f32 v107, v107, v21
    v_mul_f32 v108, v108, v22
    v_mul_f32 v109, v109, v22
    v_mul_f32 v110, v110, v22
    v_mul_f32 v111, v111, v22
    v_mul_f32 v112, v112, v23
    v_mul_f32 v113, v113, v23
    v_mul_f32 v114, v114, v23
    v_mul_f32 v115, v115, v23
    v_exp_f32 v216, v56
    v_exp_f32 v217, v57
    v_exp_f32 v218, v58
    v_exp_f32 v219, v59
    v_exp_f32 v228, v68
    v_exp_f32 v229, v69
    v_exp_f32 v230, v70
    v_exp_f32 v231, v71
    v_exp_f32 v220, v60
    v_exp_f32 v221, v61
    v_exp_f32 v222, v62
    v_exp_f32 v223, v63
    v_exp_f32 v232, v72
    v_exp_f32 v233, v73
    s_waitcnt lgkmcnt(0)
    s_barrier
    s_nop 3
    s_setpc_b64 s[50:51]
L_code_end:
.section .rodata,"a"
.p2align 6
.amdhsa_kernel standalone__gqa_block_cached__near_ridge_kernel
  .amdhsa_next_free_vgpr 512
  .amdhsa_next_free_sgpr 102
  .amdhsa_accum_offset 256
  .amdhsa_group_segment_fixed_size 0
  .amdhsa_kernarg_size 64
  .amdhsa_user_sgpr_count 2
  .amdhsa_user_sgpr_kernarg_segment_ptr 1
  .amdhsa_system_sgpr_workgroup_id_x 1
  .amdhsa_float_denorm_mode_32 3
.end_amdhsa_kernel
.text
```
